```python
import torch

def _softmax(x, axis=-1):
    return torch.softmax(x, dim=axis)
def _gelu(x):
    return torch.nn.functional.gelu(x, approximate="tanh")
def _silu(x):
    return torch.nn.functional.silu(x)
def _sigmoid(x):
    return torch.sigmoid(x)
def _layernorm(x, axis=-1, eps=1e-5):
    m = x.mean(dim=axis, keepdim=True)
    v = x.var(dim=axis, keepdim=True, unbiased=False)
    return (x - m) / torch.sqrt(v + eps)
def _scatter_add(tgt, idx, src, axis=0):
    return tgt.clone().index_add_(axis, idx, src)
def _segment_sum(src, seg, n):
    out = torch.zeros((n,) + src.shape[1:], dtype=src.dtype)
    return out.index_add_(0, seg, src)
def _pad(x, pw):
    flat = tuple(v for pair in reversed(pw) for v in pair)
    return torch.nn.functional.pad(x, flat)

kernel_name = 'concat_heads__sliding_block__softmax_full_mha__prompt'

def setup_inputs():

    _w = (lambda a: (lambda t: t.to(torch.bfloat16) if t.is_floating_point() else t)(torch.as_tensor(a)))
    def _A_setup():
        B, S, D = 1, 2048, 448
        return {
            "x": _w((lambda *s: torch.randn(*s, dtype=torch.bfloat16) * 0.2)(B, S, D)),
            "wqkv": _w((lambda *s: torch.randn(*s, dtype=torch.bfloat16) * 0.8)(D, 3 * D)),
            "wo": _w((lambda *s: torch.randn(*s, dtype=torch.bfloat16) * 3.2)(D, D)),
        }
    _A_in = _A_setup()

    def _B_setup():
        B, S, D = 1, 2048, 448
        return {
            "x": _w((lambda *s: torch.randn(*s, dtype=torch.bfloat16) * 0.2)(B, S, D)),
            "wqkv": _w((lambda *s: torch.randn(*s, dtype=torch.bfloat16) * 0.8)(D, 3 * D)),
            "wo": _w((lambda *s: torch.randn(*s, dtype=torch.bfloat16) * 3.2)(D, D)),
        }
    _B_in = _B_setup()

    return {
        "A_x": _A_in["x"],
        "A_wqkv": _A_in["wqkv"],
        "A_wo": _A_in["wo"],
        "B_x": _B_in["x"],
        "B_wqkv": _B_in["wqkv"],
        "B_wo": _B_in["wo"],
    }

def reference(A_x, A_wqkv, A_wo, B_x, B_wqkv, B_wo):
    def _A_ref(x, wqkv, wo):
        B, S, D = x.shape
        H = 16; Dh = D // H; W = 256
        qkv = (lambda x, *d: x.permute(*d))((x @ wqkv).reshape(B, S, 3, H, Dh), 2, 0, 3, 1, 4)
        q, k, v = qkv[0], qkv[1], qkv[2]
        scores = torch.einsum("bhqd,bhkd->bhqk", q, k) * (Dh ** -0.5)
        idx = torch.arange(S)
        mask = (idx[:, None] - idx[None, :] >= 0) & (idx[:, None] - idx[None, :] < W)
        scores = torch.where(mask[None, None], scores, -1e9)
        p = _softmax(scores, axis=-1)
        o = torch.einsum("bhqk,bhkd->bhqd", p, v)
        return (lambda x, *d: x.permute(*d))(o, 0, 2, 1, 3).reshape(B, S, D) @ wo

    def _B_ref(x, wqkv, wo):
        B, S, D = x.shape
        H = 16; Dh = D // H
        qkv = (lambda x, *d: x.permute(*d))((x @ wqkv).reshape(B, S, 3, H, Dh), 2, 0, 3, 1, 4)
        q, k, v = qkv[0], qkv[1], qkv[2]
        scale = Dh ** -0.5
        scores = torch.einsum("bhqd,bhkd->bhqk", q, k) * scale
        p = _softmax(scores, axis=-1)
        o = torch.einsum("bhqk,bhkd->bhqd", p, v)
        return (lambda x, *d: x.permute(*d))(o, 0, 2, 1, 3).reshape(B, S, D) @ wo

    a = _A_ref(A_x, A_wqkv, A_wo)
    b = _B_ref(B_x, B_wqkv, B_wo)
    return torch.concatenate([a, b], axis=-1)
```

```asm
; @launch grid=(256,1,1) block=(256,1,1) lds=163840
.amdgcn_target "amdgcn-amd-amdhsa--gfx950"
.text
.globl concat_heads__sliding_block__softmax_full_mha__prompt_kernel
.p2align 8
.type concat_heads__sliding_block__softmax_full_mha__prompt_kernel,@function
concat_heads__sliding_block__softmax_full_mha__prompt_kernel:
  s_cmp_ge_u32 s2, 256
  s_cbranch_scc1 L_end
  s_load_dwordx16 s[4:19], s[0:1], 0
  s_load_dwordx2 s[20:21], s[0:1], 64
  v_and_b32 v1, 63, v0
  v_lshrrev_b32 v3, 6, v0
  s_and_b32 s50, s2, 7
  v_readfirstlane_b32 s48, v3
  s_lshr_b32 s53, s2, 3
  s_and_b32 s49, s53, 1
  s_lshr_b32 s51, s53, 1
  s_mul_i32 s55, s51, 37
  s_lshr_b32 s55, s55, 8
  s_mul_i32 s55, s55, 7
  s_sub_u32 s55, s51, s55
  s_mul_i32 s56, s51, 114688
  s_mul_i32 s57, s50, 112
  v_lshrrev_b32 v3, 3, v1
  v_bfe_u32 v4, v1, 4, 1
  v_lshlrev_b32 v4, 2, v4
  v_and_b32 v5, 7, v1
  v_xor_b32 v4, v4, v5
  v_lshrrev_b32 v5, 6, v0
  v_lshl_add_u32 v6, v5, 5, v3
  v_mul_u32_u24 v6, 896, v6
  v_lshl_add_u32 v16, v4, 4, v6
  v_add_u32 v17, 6128, v16
  v_add_u32 v18, 12256, v16
  v_add_u32 v19, 18384, v16
  v_lshl_add_u32 v6, v5, 4, v3
  v_mul_u32_u24 v6, 2688, v6
  v_lshl_add_u32 v20, v4, 4, v6
  v_add_u32 v21, 20480, v20
  s_mul_i32 s58, s48, 4160
  s_mul_i32 s59, s48, 6144
  s_add_u32 s59, s59, 49920
  s_getreg_b32 s100, hwreg(HW_REG_XCC_ID)
  s_waitcnt lgkmcnt(0)
  s_cmp_eq_u32 s49, 1
  s_cselect_b32 s24, s4, s10
  s_cselect_b32 s25, s5, s11
  s_cselect_b32 s28, s6, s12
  s_cselect_b32 s29, s7, s13
  s_and_b32 s25, s25, 0xffff
  s_and_b32 s29, s29, 0xffff
  s_mov_b32 s26, 1835008
  s_mov_b32 s27, 0x20000
  s_mov_b32 s30, 1204224
  s_mov_b32 s31, 0x20000
  s_add_u32 s60, s55, 0
  s_sub_u32 s52, s60, 7
  s_min_u32 s60, s60, s52
  s_lshl_b32 s61, s60, 7
  s_add_u32 s61, s61, s56
  s_mul_i32 s62, s60, 172032
  s_add_u32 s62, s62, s57
  s_add_u32 m0, s58, 0
  s_nop 0
  buffer_load_dwordx4 v16, s[24:27], s61 offen offset:0 lds
  buffer_load_dwordx4 v17, s[24:27], s61 offen offset:1040 lds
  buffer_load_dwordx4 v18, s[24:27], s61 offen offset:2080 lds
  buffer_load_dwordx4 v19, s[24:27], s61 offen offset:3120 lds
  s_add_u32 m0, s59, 0
  s_add_u32 s63, s62, 0
  buffer_load_dwordx4 v20, s[28:31], s63 offen offset:0 lds
  buffer_load_dwordx4 v21, s[28:31], s63 offen offset:1024 lds
  s_add_u32 m0, s59, 2048
  s_add_u32 s63, s62, 896
  buffer_load_dwordx4 v20, s[28:31], s63 offen offset:0 lds
  buffer_load_dwordx4 v21, s[28:31], s63 offen offset:1024 lds
  s_add_u32 m0, s59, 4096
  s_add_u32 s63, s62, 1792
  buffer_load_dwordx4 v20, s[28:31], s63 offen offset:0 lds
  buffer_load_dwordx4 v21, s[28:31], s63 offen offset:1024 lds
  s_mov_b32 s32, s20
  s_and_b32 s33, s21, 0xffff
  s_mov_b32 s34, 18874368
  s_mov_b32 s35, 0x20000
  s_mov_b32 s36, s16
  s_and_b32 s37, s17, 0xffff
  s_mov_b32 s38, 3670016
  s_mov_b32 s39, 0x20000
  s_mov_b32 s40, s14
  s_and_b32 s41, s15, 0xffff
  s_mov_b32 s42, 401408
  s_mov_b32 s43, 0x20000
  s_mov_b32 s44, s8
  s_and_b32 s45, s9, 0xffff
  s_mov_b32 s46, 401408
  s_mov_b32 s47, 0x20000
  v_lshlrev_b32 v2, 4, v1
  s_or_b32 s52, s2, s48
  s_cmp_lg_u32 s52, 0
  s_cbranch_scc1 L_nonce_1
  s_mov_b32 s52, 17563648
  v_mov_b32 v3, 0
  buffer_load_dword v4, v3, s[32:35], s52 offen sc1
  s_waitcnt vmcnt(0)
  v_add_u32 v4, 1, v4
  v_max_u32 v4, 1, v4
  s_mov_b64 exec, 1
  global_store_dword v3, v4, s[18:19] sc1
  buffer_store_dword v4, v3, s[32:35], s52 offen sc1
  s_mov_b64 exec, -1
L_nonce_1:
  s_lshr_b32 s53, s2, 3
  s_lshl_b32 s67, s50, 1
  s_add_u32 s67, s67, s49
  s_mov_b32 s80, s51
  s_mul_i32 s54, s53, 37
  s_lshr_b32 s54, s54, 8
  s_min_u32 s60, s54, 3
  s_lshl_b32 s75, s50, 2
  s_add_u32 s75, s75, s60
  s_mul_i32 s54, s54, 7
  s_sub_u32 s74, s53, s54
  s_lshl_b32 s68, s51, 2
  s_add_u32 s68, s68, s48
  s_mov_b32 s89, s68
  s_lshl_b32 s52, s50, 1
  s_add_u32 s52, s52, 0
  s_lshl_b32 s52, s52, 6
  s_add_u32 s52, s52, s68
  s_lshl_b32 s54, s52, 12
  s_lshl_b32 s60, s49, 22
  s_add_u32 s0, s54, s60
  s_add_u32 s1, s0, 2048
  s_lshl_b32 s54, s52, 11
  s_lshl_b32 s60, s49, 21
  s_add_u32 s54, s54, s60
  s_add_u32 s3, s54, 12582912
  s_lshl_b32 s52, s50, 1
  s_add_u32 s52, s52, 1
  s_lshl_b32 s52, s52, 6
  s_add_u32 s52, s52, s68
  s_lshl_b32 s54, s52, 12
  s_lshl_b32 s60, s49, 22
  s_add_u32 s22, s54, s60
  s_add_u32 s23, s22, 2048
  s_lshl_b32 s54, s52, 11
  s_lshl_b32 s60, s49, 21
  s_add_u32 s54, s54, s60
  s_add_u32 s101, s54, 12582912
  v_and_b32 v3, 31, v1
  v_lshrrev_b32 v4, 3, v3
  v_mul_u32_u24 v4, 1040, v4
  v_and_b32 v5, 7, v3
  v_lshl_add_u32 v4, v5, 7, v4
  v_add_u32 v4, s58, v4
  v_bfe_u32 v5, v1, 1, 1
  v_lshlrev_b32 v5, 6, v5
  v_lshrrev_b32 v6, 5, v1
  v_lshlrev_b32 v6, 4, v6
  v_add_u32 v4, v4, v6
  v_xor_b32 v22, 0, v5
  v_add_u32 v22, 0, v22
  v_add_u32 v22, v22, v4
  v_xor_b32 v23, 0, v5
  v_add_u32 v23, 32, v23
  v_add_u32 v23, v23, v4
  v_xor_b32 v24, 64, v5
  v_add_u32 v24, 0, v24
  v_add_u32 v24, v24, v4
  v_xor_b32 v25, 64, v5
  v_add_u32 v25, 32, v25
  v_add_u32 v25, v25, v4
  v_lshrrev_b32 v3, 5, v1
  v_lshlrev_b32 v3, 3, v3
  v_bfe_u32 v4, v1, 2, 2
  v_add_u32 v3, v3, v4
  v_lshlrev_b32 v3, 7, v3
  v_bfe_u32 v4, v1, 4, 1
  v_lshlrev_b32 v4, 5, v4
  v_and_b32 v5, 3, v1
  v_lshl_add_u32 v4, v5, 3, v4
  v_bfe_u32 v5, v1, 3, 1
  v_lshlrev_b32 v5, 6, v5
  v_add_u32 v6, 0, v4
  v_xor_b32 v6, v6, v5
  v_add_u32 v6, v6, v3
  v_add_u32 v26, 49920, v6
  v_add_u32 v28, 99072, v6
  v_add_u32 v6, 56, v4
  v_xor_b32 v6, v6, v5
  v_add_u32 v6, v6, v3
  v_add_u32 v27, 49920, v6
  v_add_u32 v29, 99072, v6
  s_add_u32 s60, s55, 1
  s_sub_u32 s52, s60, 7
  s_min_u32 s60, s60, s52
  s_lshl_b32 s61, s60, 7
  s_add_u32 s61, s61, s56
  s_mul_i32 s62, s60, 172032
  s_add_u32 s62, s62, s57
  s_add_u32 m0, s58, 16640
  s_nop 0
  buffer_load_dwordx4 v16, s[24:27], s61 offen offset:0 lds
  buffer_load_dwordx4 v17, s[24:27], s61 offen offset:1040 lds
  buffer_load_dwordx4 v18, s[24:27], s61 offen offset:2080 lds
  buffer_load_dwordx4 v19, s[24:27], s61 offen offset:3120 lds
  s_add_u32 m0, s59, 24576
  s_add_u32 s63, s62, 0
  buffer_load_dwordx4 v20, s[28:31], s63 offen offset:0 lds
  v_and_b32 v3, 31, v1
  v_cmp_eq_u32 vcc, 28, v3
  v_mov_b32 v4, 0x3f803f80
  v_cmp_le_u32_e64 s[64:65], 28, v3
  v_cndmask_b32_e64 v10, 0, v4, vcc
  v_lshrrev_b32 v3, 3, v1
  v_bfe_u32 v4, v1, 4, 1
  v_lshlrev_b32 v4, 2, v4
  v_and_b32 v5, 7, v1
  v_xor_b32 v4, v4, v5
  v_mul_u32_u24 v3, 896, v3
  v_lshl_add_u32 v7, v4, 4, v3
  v_lshrrev_b32 v3, 5, v1
  v_lshlrev_b32 v3, 2, v3
  v_bfe_u32 v4, v1, 2, 2
  v_add_u32 v3, v3, v4
  v_lshlrev_b32 v3, 7, v3
  s_and_b32 s52, s48, 1
  s_lshl_b32 s52, s52, 6
  v_bfe_u32 v4, v1, 4, 1
  v_lshlrev_b32 v4, 5, v4
  v_and_b32 v5, 3, v1
  v_lshl_add_u32 v4, v5, 3, v4
  v_add_u32 v4, s52, v4
  v_bfe_u32 v5, v1, 3, 1
  v_lshlrev_b32 v5, 6, v5
  v_xor_b32 v4, v4, v5
  v_add_u32 v12, v3, v4
  s_lshl_b32 s52, s48, 2
  v_add_u32 v3, s52, v1
  v_cmp_eq_u32 vcc, 4, v1
  v_mov_b32 v4, s80
  s_sub_u32 s52, s80, 7
  v_cndmask_b32 v3, v3, v4, vcc
  v_add_u32 v4, s52, v1
  v_max_i32 v4, 0, v4
  v_add_u32 v4, 128, v4
  v_cmp_lt_u32 vcc, 4, v1
  s_lshl_b32 s52, s50, 4
  s_nop 0
  v_cndmask_b32 v3, v3, v4, vcc
  v_add_u32 v3, s52, v3
  v_lshlrev_b32 v8, 7, v3
  v_add_u32 v8, 16777216, v8
  v_lshrrev_b32 v3, 3, v1
  s_lshl_b32 s52, s50, 2
  v_add_u32 v3, s52, v3
  v_lshlrev_b32 v3, 7, v3
  v_and_b32 v4, 7, v1
  v_lshl_add_u32 v3, v4, 2, v3
  v_add_u32 v11, 17596416, v3
  s_lshl_b32 s86, s67, 18
  s_lshl_b32 s52, s48, 16
  s_add_u32 s86, s86, s52
  s_mov_b32 s87, 0
  v_and_b32 v3, 31, v1
  v_lshrrev_b32 v4, 5, v1
  v_lshlrev_b32 v4, 2, v4
  v_sub_u32 v3, v3, v4
  v_mov_b32 v4, 0xf149f2ca
  v_cmp_le_i32_e64 s[90:91], 0, v3
  v_cmp_le_i32_e64 s[92:93], 1, v3
  v_cmp_le_i32_e64 s[94:95], 2, v3
  v_cndmask_b32_e64 v240, v4, 0, s[90:91]
  v_cmp_le_i32_e64 s[90:91], 3, v3
  v_cndmask_b32_e64 v241, v4, 0, s[92:93]
  v_cmp_le_i32_e64 s[92:93], 8, v3
  v_cndmask_b32_e64 v242, v4, 0, s[94:95]
  v_cmp_le_i32_e64 s[94:95], 9, v3
  v_cndmask_b32_e64 v243, v4, 0, s[90:91]
  v_cmp_le_i32_e64 s[90:91], 10, v3
  v_cndmask_b32_e64 v244, v4, 0, s[92:93]
  v_cmp_le_i32_e64 s[92:93], 11, v3
  v_cndmask_b32_e64 v245, v4, 0, s[94:95]
  v_cmp_le_i32_e64 s[94:95], 16, v3
  v_cndmask_b32_e64 v246, v4, 0, s[90:91]
  v_cmp_le_i32_e64 s[90:91], 17, v3
  v_cndmask_b32_e64 v247, v4, 0, s[92:93]
  v_cmp_le_i32_e64 s[92:93], 18, v3
  v_cndmask_b32_e64 v248, v4, 0, s[94:95]
  v_cmp_le_i32_e64 s[94:95], 19, v3
  v_cndmask_b32_e64 v249, v4, 0, s[90:91]
  v_cmp_le_i32_e64 s[90:91], 24, v3
  v_cndmask_b32_e64 v250, v4, 0, s[92:93]
  v_cmp_le_i32_e64 s[92:93], 25, v3
  v_cndmask_b32_e64 v251, v4, 0, s[94:95]
  v_cmp_le_i32_e64 s[94:95], 26, v3
  v_cndmask_b32_e64 v252, v4, 0, s[90:91]
  v_cmp_le_i32_e64 s[90:91], 27, v3
  v_cndmask_b32_e64 v253, v4, 0, s[92:93]
  s_nop 0
  v_cndmask_b32_e64 v254, v4, 0, s[94:95]
  s_nop 0
  v_cndmask_b32_e64 v255, v4, 0, s[90:91]
  buffer_load_dwordx4 v21, s[28:31], s63 offen offset:1024 lds
  s_add_u32 m0, s59, 26624
  s_add_u32 s63, s62, 896
  buffer_load_dwordx4 v20, s[28:31], s63 offen offset:0 lds
  buffer_load_dwordx4 v21, s[28:31], s63 offen offset:1024 lds
  s_add_u32 m0, s59, 28672
  s_add_u32 s63, s62, 1792
  buffer_load_dwordx4 v20, s[28:31], s63 offen offset:0 lds
  buffer_load_dwordx4 v21, s[28:31], s63 offen offset:1024 lds
  s_waitcnt vmcnt(10)
  s_waitcnt lgkmcnt(0)
  s_barrier
  ds_read_b128 v[32:35], v22 offset:0
  ds_read_b64_tr_b16 v[40:41], v26 offset:0
  ds_read_b64_tr_b16 v[42:43], v26 offset:512
  ds_read_b64_tr_b16 v[44:45], v26 offset:2048
  ds_read_b64_tr_b16 v[46:47], v26 offset:2560
  ds_read_b64_tr_b16 v[48:49], v26 offset:4096
  ds_read_b64_tr_b16 v[50:51], v26 offset:4608
  ds_read_b64_tr_b16 v[52:53], v27 offset:0
  ds_read_b64_tr_b16 v[54:55], v27 offset:512
  ds_read_b64_tr_b16 v[56:57], v27 offset:2048
  ds_read_b64_tr_b16 v[58:59], v27 offset:2560
  ds_read_b64_tr_b16 v[60:61], v27 offset:4096
  ds_read_b64_tr_b16 v[62:63], v27 offset:4608
  s_add_u32 s60, s55, 2
  s_sub_u32 s52, s60, 7
  s_min_u32 s60, s60, s52
  s_lshl_b32 s61, s60, 7
  s_add_u32 s61, s61, s56
  s_mul_i32 s62, s60, 172032
  s_add_u32 s62, s62, s57
  s_add_u32 m0, s58, 33280
  s_nop 0
  buffer_load_dwordx4 v16, s[24:27], s61 offen offset:0 lds
  s_waitcnt lgkmcnt(0)
  v_mfma_f32_32x32x16_bf16 v[88:103], v[40:43], v[32:35], 0
  ds_read_b128 v[36:39], v23 offset:0
  ds_read_b64_tr_b16 v[64:65], v26 offset:6144
  ds_read_b64_tr_b16 v[66:67], v26 offset:6656
  v_mfma_f32_32x32x16_bf16 v[104:119], v[44:47], v[32:35], 0
  ds_read_b64_tr_b16 v[68:69], v26 offset:8192
  ds_read_b64_tr_b16 v[70:71], v26 offset:8704
  buffer_load_dwordx4 v17, s[24:27], s61 offen offset:1040 lds
  v_mfma_f32_32x32x16_bf16 v[120:135], v[32:35], v[48:51], 0
  ds_read_b64_tr_b16 v[72:73], v26 offset:10240
  ds_read_b64_tr_b16 v[74:75], v26 offset:10752
  v_mfma_f32_32x32x16_bf16 v[136:151], v[52:55], v[32:35], 0
  ds_read_b64_tr_b16 v[76:77], v27 offset:6144
  ds_read_b64_tr_b16 v[78:79], v27 offset:6656
  buffer_load_dwordx4 v18, s[24:27], s61 offen offset:2080 lds
  v_mfma_f32_32x32x16_bf16 v[152:167], v[56:59], v[32:35], 0
  ds_read_b64_tr_b16 v[80:81], v27 offset:8192
  ds_read_b64_tr_b16 v[82:83], v27 offset:8704
  v_mfma_f32_32x32x16_bf16 v[168:183], v[32:35], v[60:63], 0
  ds_read_b64_tr_b16 v[84:85], v27 offset:10240
  ds_read_b64_tr_b16 v[86:87], v27 offset:10752
  buffer_load_dwordx4 v19, s[24:27], s61 offen offset:3120 lds
  s_waitcnt lgkmcnt(0)
  v_mfma_f32_32x32x16_bf16 v[88:103], v[64:67], v[36:39], v[88:103]
  ds_read_b128 v[32:35], v24 offset:0
  ds_read_b64_tr_b16 v[40:41], v26 offset:12288
  ds_read_b64_tr_b16 v[42:43], v26 offset:12800
  v_mfma_f32_32x32x16_bf16 v[104:119], v[68:71], v[36:39], v[104:119]
  ds_read_b64_tr_b16 v[44:45], v26 offset:14336
  ds_read_b64_tr_b16 v[46:47], v26 offset:14848
  s_add_u32 m0, s59, 49152
  s_add_u32 s63, s62, 0
  buffer_load_dwordx4 v20, s[28:31], s63 offen offset:0 lds
  v_mfma_f32_32x32x16_bf16 v[120:135], v[36:39], v[72:75], v[120:135]
  ds_read_b64_tr_b16 v[48:49], v26 offset:16384
  ds_read_b64_tr_b16 v[50:51], v26 offset:16896
  v_mfma_f32_32x32x16_bf16 v[136:151], v[76:79], v[36:39], v[136:151]
  ds_read_b64_tr_b16 v[52:53], v27 offset:12288
  ds_read_b64_tr_b16 v[54:55], v27 offset:12800
  buffer_load_dwordx4 v21, s[28:31], s63 offen offset:1024 lds
  v_mfma_f32_32x32x16_bf16 v[152:167], v[80:83], v[36:39], v[152:167]
  ds_read_b64_tr_b16 v[56:57], v27 offset:14336
  ds_read_b64_tr_b16 v[58:59], v27 offset:14848
  v_mfma_f32_32x32x16_bf16 v[168:183], v[36:39], v[84:87], v[168:183]
  ds_read_b64_tr_b16 v[60:61], v27 offset:16384
  ds_read_b64_tr_b16 v[62:63], v27 offset:16896
  s_add_u32 m0, s59, 51200
  s_add_u32 s63, s62, 896
  buffer_load_dwordx4 v20, s[28:31], s63 offen offset:0 lds
  s_waitcnt lgkmcnt(0)
  v_mfma_f32_32x32x16_bf16 v[88:103], v[40:43], v[32:35], v[88:103]
  ds_read_b128 v[36:39], v25 offset:0
  ds_read_b64_tr_b16 v[64:65], v26 offset:18432
  ds_read_b64_tr_b16 v[66:67], v26 offset:18944
  v_mfma_f32_32x32x16_bf16 v[104:119], v[44:47], v[32:35], v[104:119]
  ds_read_b64_tr_b16 v[68:69], v26 offset:20480
  ds_read_b64_tr_b16 v[70:71], v26 offset:20992
  buffer_load_dwordx4 v21, s[28:31], s63 offen offset:1024 lds
  v_mfma_f32_32x32x16_bf16 v[120:135], v[32:35], v[48:51], v[120:135]
  ds_read_b64_tr_b16 v[72:73], v26 offset:22528
  ds_read_b64_tr_b16 v[74:75], v26 offset:23040
  v_mfma_f32_32x32x16_bf16 v[136:151], v[52:55], v[32:35], v[136:151]
  ds_read_b64_tr_b16 v[76:77], v27 offset:18432
  ds_read_b64_tr_b16 v[78:79], v27 offset:18944
  s_add_u32 m0, s59, 53248
  s_add_u32 s63, s62, 1792
  buffer_load_dwordx4 v20, s[28:31], s63 offen offset:0 lds
  v_mfma_f32_32x32x16_bf16 v[152:167], v[56:59], v[32:35], v[152:167]
  ds_read_b64_tr_b16 v[80:81], v27 offset:20480
  ds_read_b64_tr_b16 v[82:83], v27 offset:20992
  v_mfma_f32_32x32x16_bf16 v[168:183], v[32:35], v[60:63], v[168:183]
  ds_read_b64_tr_b16 v[84:85], v27 offset:22528
  ds_read_b64_tr_b16 v[86:87], v27 offset:23040
  buffer_load_dwordx4 v21, s[28:31], s63 offen offset:1024 lds
  s_waitcnt vmcnt(10)
  s_waitcnt lgkmcnt(0)
  s_barrier
  v_mfma_f32_32x32x16_bf16 v[88:103], v[64:67], v[36:39], v[88:103]
  ds_read_b128 v[32:35], v22 offset:16640
  ds_read_b64_tr_b16 v[40:41], v26 offset:24576
  ds_read_b64_tr_b16 v[42:43], v26 offset:25088
  v_mfma_f32_32x32x16_bf16 v[104:119], v[68:71], v[36:39], v[104:119]
  ds_read_b64_tr_b16 v[44:45], v26 offset:26624
  ds_read_b64_tr_b16 v[46:47], v26 offset:27136
  s_add_u32 s60, s55, 3
  s_sub_u32 s52, s60, 7
  s_min_u32 s60, s60, s52
  s_lshl_b32 s61, s60, 7
  s_add_u32 s61, s61, s56
  s_mul_i32 s62, s60, 172032
  s_add_u32 s62, s62, s57
  s_add_u32 m0, s58, 0
  s_nop 0
  buffer_load_dwordx4 v16, s[24:27], s61 offen offset:0 lds
  v_mfma_f32_32x32x16_bf16 v[120:135], v[36:39], v[72:75], v[120:135]
  ds_read_b64_tr_b16 v[48:49], v26 offset:28672
  ds_read_b64_tr_b16 v[50:51], v26 offset:29184
  v_mfma_f32_32x32x16_bf16 v[136:151], v[76:79], v[36:39], v[136:151]
  ds_read_b64_tr_b16 v[52:53], v27 offset:24576
  ds_read_b64_tr_b16 v[54:55], v27 offset:25088
  buffer_load_dwordx4 v17, s[24:27], s61 offen offset:1040 lds
  v_mfma_f32_32x32x16_bf16 v[152:167], v[80:83], v[36:39], v[152:167]
  ds_read_b64_tr_b16 v[56:57], v27 offset:26624
  ds_read_b64_tr_b16 v[58:59], v27 offset:27136
  v_mfma_f32_32x32x16_bf16 v[168:183], v[36:39], v[84:87], v[168:183]
  ds_read_b64_tr_b16 v[60:61], v27 offset:28672
  ds_read_b64_tr_b16 v[62:63], v27 offset:29184
  buffer_load_dwordx4 v18, s[24:27], s61 offen offset:2080 lds
  s_waitcnt lgkmcnt(0)
  v_mfma_f32_32x32x16_bf16 v[88:103], v[40:43], v[32:35], v[88:103]
  ds_read_b128 v[36:39], v23 offset:16640
  ds_read_b64_tr_b16 v[64:65], v26 offset:30720
  ds_read_b64_tr_b16 v[66:67], v26 offset:31232
  v_mfma_f32_32x32x16_bf16 v[104:119], v[44:47], v[32:35], v[104:119]
  ds_read_b64_tr_b16 v[68:69], v26 offset:32768
  ds_read_b64_tr_b16 v[70:71], v26 offset:33280
  buffer_load_dwordx4 v19, s[24:27], s61 offen offset:3120 lds
  v_mfma_f32_32x32x16_bf16 v[120:135], v[32:35], v[48:51], v[120:135]
  ds_read_b64_tr_b16 v[72:73], v26 offset:34816
  ds_read_b64_tr_b16 v[74:75], v26 offset:35328
  v_mfma_f32_32x32x16_bf16 v[136:151], v[52:55], v[32:35], v[136:151]
  ds_read_b64_tr_b16 v[76:77], v27 offset:30720
  ds_read_b64_tr_b16 v[78:79], v27 offset:31232
  s_add_u32 m0, s59, 0
  s_add_u32 s63, s62, 0
  buffer_load_dwordx4 v20, s[28:31], s63 offen offset:0 lds
  v_mfma_f32_32x32x16_bf16 v[152:167], v[56:59], v[32:35], v[152:167]
  ds_read_b64_tr_b16 v[80:81], v27 offset:32768
  ds_read_b64_tr_b16 v[82:83], v27 offset:33280
  v_mfma_f32_32x32x16_bf16 v[168:183], v[32:35], v[60:63], v[168:183]
  ds_read_b64_tr_b16 v[84:85], v27 offset:34816
  ds_read_b64_tr_b16 v[86:87], v27 offset:35328
  buffer_load_dwordx4 v21, s[28:31], s63 offen offset:1024 lds
  s_waitcnt lgkmcnt(0)
  v_mfma_f32_32x32x16_bf16 v[88:103], v[64:67], v[36:39], v[88:103]
  ds_read_b128 v[32:35], v24 offset:16640
  ds_read_b64_tr_b16 v[40:41], v26 offset:36864
  ds_read_b64_tr_b16 v[42:43], v26 offset:37376
  v_mfma_f32_32x32x16_bf16 v[104:119], v[68:71], v[36:39], v[104:119]
  ds_read_b64_tr_b16 v[44:45], v26 offset:38912
  ds_read_b64_tr_b16 v[46:47], v26 offset:39424
  s_add_u32 m0, s59, 2048
  s_add_u32 s63, s62, 896
  buffer_load_dwordx4 v20, s[28:31], s63 offen offset:0 lds
  v_mfma_f32_32x32x16_bf16 v[120:135], v[36:39], v[72:75], v[120:135]
  ds_read_b64_tr_b16 v[48:49], v26 offset:40960
  ds_read_b64_tr_b16 v[50:51], v26 offset:41472
  v_mfma_f32_32x32x16_bf16 v[136:151], v[76:79], v[36:39], v[136:151]
  ds_read_b64_tr_b16 v[52:53], v27 offset:36864
  ds_read_b64_tr_b16 v[54:55], v27 offset:37376
  buffer_load_dwordx4 v21, s[28:31], s63 offen offset:1024 lds
  v_mfma_f32_32x32x16_bf16 v[152:167], v[80:83], v[36:39], v[152:167]
  ds_read_b64_tr_b16 v[56:57], v27 offset:38912
  ds_read_b64_tr_b16 v[58:59], v27 offset:39424
  v_mfma_f32_32x32x16_bf16 v[168:183], v[36:39], v[84:87], v[168:183]
  ds_read_b64_tr_b16 v[60:61], v27 offset:40960
  ds_read_b64_tr_b16 v[62:63], v27 offset:41472
  s_add_u32 m0, s59, 4096
  s_add_u32 s63, s62, 1792
  buffer_load_dwordx4 v20, s[28:31], s63 offen offset:0 lds
  s_waitcnt lgkmcnt(0)
  v_mfma_f32_32x32x16_bf16 v[88:103], v[40:43], v[32:35], v[88:103]
  ds_read_b128 v[36:39], v25 offset:16640
  ds_read_b64_tr_b16 v[64:65], v26 offset:43008
  ds_read_b64_tr_b16 v[66:67], v26 offset:43520
  v_mfma_f32_32x32x16_bf16 v[104:119], v[44:47], v[32:35], v[104:119]
  ds_read_b64_tr_b16 v[68:69], v26 offset:45056
  ds_read_b64_tr_b16 v[70:71], v26 offset:45568
  buffer_load_dwordx4 v21, s[28:31], s63 offen offset:1024 lds
  v_mfma_f32_32x32x16_bf16 v[120:135], v[32:35], v[48:51], v[120:135]
  ds_read_b64_tr_b16 v[72:73], v26 offset:47104
  ds_read_b64_tr_b16 v[74:75], v26 offset:47616
  v_mfma_f32_32x32x16_bf16 v[136:151], v[52:55], v[32:35], v[136:151]
  ds_read_b64_tr_b16 v[76:77], v27 offset:43008
  ds_read_b64_tr_b16 v[78:79], v27 offset:43520
  v_mfma_f32_32x32x16_bf16 v[152:167], v[56:59], v[32:35], v[152:167]
  ds_read_b64_tr_b16 v[80:81], v27 offset:45056
  ds_read_b64_tr_b16 v[82:83], v27 offset:45568
  v_mfma_f32_32x32x16_bf16 v[168:183], v[32:35], v[60:63], v[168:183]
  ds_read_b64_tr_b16 v[84:85], v27 offset:47104
  ds_read_b64_tr_b16 v[86:87], v27 offset:47616
  s_waitcnt vmcnt(10)
  s_waitcnt lgkmcnt(0)
  s_barrier
  v_mfma_f32_32x32x16_bf16 v[88:103], v[64:67], v[36:39], v[88:103]
  ds_read_b128 v[32:35], v22 offset:33280
  ds_read_b64_tr_b16 v[40:41], v28 offset:0
  ds_read_b64_tr_b16 v[42:43], v28 offset:512
  v_mfma_f32_32x32x16_bf16 v[104:119], v[68:71], v[36:39], v[104:119]
  ds_read_b64_tr_b16 v[44:45], v28 offset:2048
  ds_read_b64_tr_b16 v[46:47], v28 offset:2560
  s_add_u32 s60, s55, 4
  s_sub_u32 s52, s60, 7
  s_min_u32 s60, s60, s52
  s_lshl_b32 s61, s60, 7
  s_add_u32 s61, s61, s56
  s_mul_i32 s62, s60, 172032
  s_add_u32 s62, s62, s57
  s_add_u32 m0, s58, 16640
  s_nop 0
  buffer_load_dwordx4 v16, s[24:27], s61 offen offset:0 lds
  v_mfma_f32_32x32x16_bf16 v[120:135], v[36:39], v[72:75], v[120:135]
  ds_read_b64_tr_b16 v[48:49], v28 offset:4096
  ds_read_b64_tr_b16 v[50:51], v28 offset:4608
  v_mfma_f32_32x32x16_bf16 v[136:151], v[76:79], v[36:39], v[136:151]
  ds_read_b64_tr_b16 v[52:53], v29 offset:0
  ds_read_b64_tr_b16 v[54:55], v29 offset:512
  buffer_load_dwordx4 v17, s[24:27], s61 offen offset:1040 lds
  v_mfma_f32_32x32x16_bf16 v[152:167], v[80:83], v[36:39], v[152:167]
  ds_read_b64_tr_b16 v[56:57], v29 offset:2048
  ds_read_b64_tr_b16 v[58:59], v29 offset:2560
  v_mfma_f32_32x32x16_bf16 v[168:183], v[36:39], v[84:87], v[168:183]
  ds_read_b64_tr_b16 v[60:61], v29 offset:4096
  ds_read_b64_tr_b16 v[62:63], v29 offset:4608
  buffer_load_dwordx4 v18, s[24:27], s61 offen offset:2080 lds
  v_mov_b32 v3, 0
  global_load_dword v6, v3, s[18:19] sc1
  s_waitcnt lgkmcnt(0)
  v_mfma_f32_32x32x16_bf16 v[88:103], v[40:43], v[32:35], v[88:103]
  ds_read_b128 v[36:39], v23 offset:33280
  ds_read_b64_tr_b16 v[64:65], v28 offset:6144
  ds_read_b64_tr_b16 v[66:67], v28 offset:6656
  v_mfma_f32_32x32x16_bf16 v[104:119], v[44:47], v[32:35], v[104:119]
  ds_read_b64_tr_b16 v[68:69], v28 offset:8192
  ds_read_b64_tr_b16 v[70:71], v28 offset:8704
  buffer_load_dwordx4 v19, s[24:27], s61 offen offset:3120 lds
  v_mfma_f32_32x32x16_bf16 v[120:135], v[32:35], v[48:51], v[120:135]
  ds_read_b64_tr_b16 v[72:73], v28 offset:10240
  ds_read_b64_tr_b16 v[74:75], v28 offset:10752
  v_mfma_f32_32x32x16_bf16 v[136:151], v[52:55], v[32:35], v[136:151]
  ds_read_b64_tr_b16 v[76:77], v29 offset:6144
  ds_read_b64_tr_b16 v[78:79], v29 offset:6656
  s_add_u32 m0, s59, 24576
  s_add_u32 s63, s62, 0
  buffer_load_dwordx4 v20, s[28:31], s63 offen offset:0 lds
  v_mfma_f32_32x32x16_bf16 v[152:167], v[56:59], v[32:35], v[152:167]
  ds_read_b64_tr_b16 v[80:81], v29 offset:8192
  ds_read_b64_tr_b16 v[82:83], v29 offset:8704
  v_mfma_f32_32x32x16_bf16 v[168:183], v[32:35], v[60:63], v[168:183]
  ds_read_b64_tr_b16 v[84:85], v29 offset:10240
  ds_read_b64_tr_b16 v[86:87], v29 offset:10752
  buffer_load_dwordx4 v21, s[28:31], s63 offen offset:1024 lds
  s_waitcnt lgkmcnt(0)
  v_mfma_f32_32x32x16_bf16 v[88:103], v[64:67], v[36:39], v[88:103]
  ds_read_b128 v[32:35], v24 offset:33280
  ds_read_b64_tr_b16 v[40:41], v28 offset:12288
  ds_read_b64_tr_b16 v[42:43], v28 offset:12800
  v_mfma_f32_32x32x16_bf16 v[104:119], v[68:71], v[36:39], v[104:119]
  ds_read_b64_tr_b16 v[44:45], v28 offset:14336
  ds_read_b64_tr_b16 v[46:47], v28 offset:14848
  s_add_u32 m0, s59, 26624
  s_add_u32 s63, s62, 896
  buffer_load_dwordx4 v20, s[28:31], s63 offen offset:0 lds
  v_mfma_f32_32x32x16_bf16 v[120:135], v[36:39], v[72:75], v[120:135]
  ds_read_b64_tr_b16 v[48:49], v28 offset:16384
  ds_read_b64_tr_b16 v[50:51], v28 offset:16896
  v_mfma_f32_32x32x16_bf16 v[136:151], v[76:79], v[36:39], v[136:151]
  ds_read_b64_tr_b16 v[52:53], v29 offset:12288
  ds_read_b64_tr_b16 v[54:55], v29 offset:12800
  buffer_load_dwordx4 v21, s[28:31], s63 offen offset:1024 lds
  v_mfma_f32_32x32x16_bf16 v[152:167], v[80:83], v[36:39], v[152:167]
  ds_read_b64_tr_b16 v[56:57], v29 offset:14336
  ds_read_b64_tr_b16 v[58:59], v29 offset:14848
  v_mfma_f32_32x32x16_bf16 v[168:183], v[36:39], v[84:87], v[168:183]
  ds_read_b64_tr_b16 v[60:61], v29 offset:16384
  ds_read_b64_tr_b16 v[62:63], v29 offset:16896
  s_add_u32 m0, s59, 28672
  s_add_u32 s63, s62, 1792
  buffer_load_dwordx4 v20, s[28:31], s63 offen offset:0 lds
  s_waitcnt lgkmcnt(0)
  v_mfma_f32_32x32x16_bf16 v[88:103], v[40:43], v[32:35], v[88:103]
  ds_read_b128 v[36:39], v25 offset:33280
  ds_read_b64_tr_b16 v[64:65], v28 offset:18432
  ds_read_b64_tr_b16 v[66:67], v28 offset:18944
  v_mfma_f32_32x32x16_bf16 v[104:119], v[44:47], v[32:35], v[104:119]
  ds_read_b64_tr_b16 v[68:69], v28 offset:20480
  ds_read_b64_tr_b16 v[70:71], v28 offset:20992
  buffer_load_dwordx4 v21, s[28:31], s63 offen offset:1024 lds
  v_mfma_f32_32x32x16_bf16 v[120:135], v[32:35], v[48:51], v[120:135]
  ds_read_b64_tr_b16 v[72:73], v28 offset:22528
  ds_read_b64_tr_b16 v[74:75], v28 offset:23040
  v_mfma_f32_32x32x16_bf16 v[136:151], v[52:55], v[32:35], v[136:151]
  ds_read_b64_tr_b16 v[76:77], v29 offset:18432
  ds_read_b64_tr_b16 v[78:79], v29 offset:18944
  v_mfma_f32_32x32x16_bf16 v[152:167], v[56:59], v[32:35], v[152:167]
  ds_read_b64_tr_b16 v[80:81], v29 offset:20480
  ds_read_b64_tr_b16 v[82:83], v29 offset:20992
  v_mfma_f32_32x32x16_bf16 v[168:183], v[32:35], v[60:63], v[168:183]
  ds_read_b64_tr_b16 v[84:85], v29 offset:22528
  ds_read_b64_tr_b16 v[86:87], v29 offset:23040
  s_waitcnt vmcnt(11)
  s_waitcnt lgkmcnt(0)
  s_barrier
  v_mfma_f32_32x32x16_bf16 v[88:103], v[64:67], v[36:39], v[88:103]
  ds_read_b128 v[32:35], v22 offset:0
  ds_read_b64_tr_b16 v[40:41], v26 offset:0
  ds_read_b64_tr_b16 v[42:43], v26 offset:512
  v_mfma_f32_32x32x16_bf16 v[104:119], v[68:71], v[36:39], v[104:119]
  ds_read_b64_tr_b16 v[44:45], v26 offset:2048
  ds_read_b64_tr_b16 v[46:47], v26 offset:2560
  s_add_u32 s60, s55, 5
  s_sub_u32 s52, s60, 7
  s_min_u32 s60, s60, s52
  s_lshl_b32 s61, s60, 7
  s_add_u32 s61, s61, s56
  s_mul_i32 s62, s60, 172032
  s_add_u32 s62, s62, s57
  s_add_u32 m0, s58, 33280
  s_nop 0
  buffer_load_dwordx4 v16, s[24:27], s61 offen offset:0 lds
  v_mfma_f32_32x32x16_bf16 v[120:135], v[36:39], v[72:75], v[120:135]
  ds_read_b64_tr_b16 v[48:49], v26 offset:4096
  ds_read_b64_tr_b16 v[50:51], v26 offset:4608
  v_mfma_f32_32x32x16_bf16 v[136:151], v[76:79], v[36:39], v[136:151]
  ds_read_b64_tr_b16 v[52:53], v27 offset:0
  ds_read_b64_tr_b16 v[54:55], v27 offset:512
  buffer_load_dwordx4 v17, s[24:27], s61 offen offset:1040 lds
  v_mfma_f32_32x32x16_bf16 v[152:167], v[80:83], v[36:39], v[152:167]
  ds_read_b64_tr_b16 v[56:57], v27 offset:2048
  ds_read_b64_tr_b16 v[58:59], v27 offset:2560
  v_mfma_f32_32x32x16_bf16 v[168:183], v[36:39], v[84:87], v[168:183]
  ds_read_b64_tr_b16 v[60:61], v27 offset:4096
  ds_read_b64_tr_b16 v[62:63], v27 offset:4608
  buffer_load_dwordx4 v18, s[24:27], s61 offen offset:2080 lds
  s_waitcnt vmcnt(10)
  v_readfirstlane_b32 s66, v6
  s_mov_b32 s73, 0
  s_cmp_lg_u32 s66, 0
  s_cbranch_scc1 L_nd_3
L_n_2:
  global_load_dword v6, v3, s[18:19] sc1
  s_add_u32 s73, s73, 1
  s_waitcnt vmcnt(0)
  v_readfirstlane_b32 s66, v6
  s_cmp_gt_u32 s73, 262144
  s_cbranch_scc1 L_nd_3
  s_cmp_eq_u32 s66, 0
  s_cbranch_scc1 L_n_2
L_nd_3:
  s_add_u32 s52, s100, 1
  s_lshl_b32 s52, s52, 24
  s_add_u32 s95, s66, s52
  s_lshr_b32 s52, s2, 3
  s_lshr_b32 s53, s52, 3
  s_lshl_b32 s54, s50, 2
  s_add_u32 s53, s53, s54
  s_lshl_b32 s53, s53, 7
  s_and_b32 s52, s52, 7
  s_lshl_b32 s52, s52, 2
  s_add_u32 s53, s53, s52
  s_add_u32 s53, s53, 17596416
  s_cmp_eq_u32 s48, 0
  s_cselect_b32 s53, s53, 18874368
  v_mov_b32 v3, 0
  v_mov_b32 v4, s95
  s_mov_b64 exec, 1
  buffer_store_dword v4, v3, s[32:35], s53 offen sc1
  s_mov_b64 exec, -1
  s_waitcnt lgkmcnt(0)
  v_mfma_f32_32x32x16_bf16 v[88:103], v[40:43], v[32:35], v[88:103]
  ds_read_b128 v[36:39], v23 offset:0
  ds_read_b64_tr_b16 v[64:65], v26 offset:6144
  ds_read_b64_tr_b16 v[66:67], v26 offset:6656
  v_mfma_f32_32x32x16_bf16 v[104:119], v[44:47], v[32:35], v[104:119]
  ds_read_b64_tr_b16 v[68:69], v26 offset:8192
  ds_read_b64_tr_b16 v[70:71], v26 offset:8704
  buffer_load_dwordx4 v19, s[24:27], s61 offen offset:3120 lds
  v_mfma_f32_32x32x16_bf16 v[120:135], v[32:35], v[48:51], v[120:135]
  ds_read_b64_tr_b16 v[72:73], v26 offset:10240
  ds_read_b64_tr_b16 v[74:75], v26 offset:10752
  v_mfma_f32_32x32x16_bf16 v[136:151], v[52:55], v[32:35], v[136:151]
  ds_read_b64_tr_b16 v[76:77], v27 offset:6144
  ds_read_b64_tr_b16 v[78:79], v27 offset:6656
  s_add_u32 m0, s59, 49152
  s_add_u32 s63, s62, 0
  buffer_load_dwordx4 v20, s[28:31], s63 offen offset:0 lds
  v_mfma_f32_32x32x16_bf16 v[152:167], v[56:59], v[32:35], v[152:167]
  ds_read_b64_tr_b16 v[80:81], v27 offset:8192
  ds_read_b64_tr_b16 v[82:83], v27 offset:8704
  v_mfma_f32_32x32x16_bf16 v[168:183], v[32:35], v[60:63], v[168:183]
  ds_read_b64_tr_b16 v[84:85], v27 offset:10240
  ds_read_b64_tr_b16 v[86:87], v27 offset:10752
  buffer_load_dwordx4 v21, s[28:31], s63 offen offset:1024 lds
  s_waitcnt lgkmcnt(0)
  v_mfma_f32_32x32x16_bf16 v[88:103], v[64:67], v[36:39], v[88:103]
  ds_read_b128 v[32:35], v24 offset:0
  ds_read_b64_tr_b16 v[40:41], v26 offset:12288
  ds_read_b64_tr_b16 v[42:43], v26 offset:12800
  v_mfma_f32_32x32x16_bf16 v[104:119], v[68:71], v[36:39], v[104:119]
  ds_read_b64_tr_b16 v[44:45], v26 offset:14336
  ds_read_b64_tr_b16 v[46:47], v26 offset:14848
  s_add_u32 m0, s59, 51200
  s_add_u32 s63, s62, 896
  buffer_load_dwordx4 v20, s[28:31], s63 offen offset:0 lds
  v_mfma_f32_32x32x16_bf16 v[120:135], v[36:39], v[72:75], v[120:135]
  ds_read_b64_tr_b16 v[48:49], v26 offset:16384
  ds_read_b64_tr_b16 v[50:51], v26 offset:16896
  v_mfma_f32_32x32x16_bf16 v[136:151], v[76:79], v[36:39], v[136:151]
  ds_read_b64_tr_b16 v[52:53], v27 offset:12288
  ds_read_b64_tr_b16 v[54:55], v27 offset:12800
  buffer_load_dwordx4 v21, s[28:31], s63 offen offset:1024 lds
  v_mfma_f32_32x32x16_bf16 v[152:167], v[80:83], v[36:39], v[152:167]
  ds_read_b64_tr_b16 v[56:57], v27 offset:14336
  ds_read_b64_tr_b16 v[58:59], v27 offset:14848
  v_mfma_f32_32x32x16_bf16 v[168:183], v[36:39], v[84:87], v[168:183]
  ds_read_b64_tr_b16 v[60:61], v27 offset:16384
  ds_read_b64_tr_b16 v[62:63], v27 offset:16896
  s_add_u32 m0, s59, 53248
  s_add_u32 s63, s62, 1792
  buffer_load_dwordx4 v20, s[28:31], s63 offen offset:0 lds
  s_waitcnt lgkmcnt(0)
  v_mfma_f32_32x32x16_bf16 v[88:103], v[40:43], v[32:35], v[88:103]
  ds_read_b128 v[36:39], v25 offset:0
  ds_read_b64_tr_b16 v[64:65], v26 offset:18432
  ds_read_b64_tr_b16 v[66:67], v26 offset:18944
  v_mfma_f32_32x32x16_bf16 v[104:119], v[44:47], v[32:35], v[104:119]
  ds_read_b64_tr_b16 v[68:69], v26 offset:20480
  ds_read_b64_tr_b16 v[70:71], v26 offset:20992
  buffer_load_dwordx4 v21, s[28:31], s63 offen offset:1024 lds
  v_mfma_f32_32x32x16_bf16 v[120:135], v[32:35], v[48:51], v[120:135]
  ds_read_b64_tr_b16 v[72:73], v26 offset:22528
  ds_read_b64_tr_b16 v[74:75], v26 offset:23040
  v_mfma_f32_32x32x16_bf16 v[136:151], v[52:55], v[32:35], v[136:151]
  ds_read_b64_tr_b16 v[76:77], v27 offset:18432
  ds_read_b64_tr_b16 v[78:79], v27 offset:18944
  v_mfma_f32_32x32x16_bf16 v[152:167], v[56:59], v[32:35], v[152:167]
  ds_read_b64_tr_b16 v[80:81], v27 offset:20480
  ds_read_b64_tr_b16 v[82:83], v27 offset:20992
  v_mfma_f32_32x32x16_bf16 v[168:183], v[32:35], v[60:63], v[168:183]
  ds_read_b64_tr_b16 v[84:85], v27 offset:22528
  ds_read_b64_tr_b16 v[86:87], v27 offset:23040
  s_waitcnt vmcnt(11)
  s_waitcnt lgkmcnt(0)
  s_barrier
  v_mfma_f32_32x32x16_bf16 v[88:103], v[64:67], v[36:39], v[88:103]
  ds_read_b128 v[32:35], v22 offset:16640
  ds_read_b64_tr_b16 v[40:41], v26 offset:24576
  ds_read_b64_tr_b16 v[42:43], v26 offset:25088
  v_mfma_f32_32x32x16_bf16 v[104:119], v[68:71], v[36:39], v[104:119]
  ds_read_b64_tr_b16 v[44:45], v26 offset:26624
  ds_read_b64_tr_b16 v[46:47], v26 offset:27136
  s_add_u32 s60, s55, 6
  s_sub_u32 s52, s60, 7
  s_min_u32 s60, s60, s52
  s_lshl_b32 s61, s60, 7
  s_add_u32 s61, s61, s56
  s_mul_i32 s62, s60, 172032
  s_add_u32 s62, s62, s57
  s_add_u32 m0, s58, 0
  s_nop 0
  buffer_load_dwordx4 v16, s[24:27], s61 offen offset:0 lds
  v_mfma_f32_32x32x16_bf16 v[120:135], v[36:39], v[72:75], v[120:135]
  ds_read_b64_tr_b16 v[48:49], v26 offset:28672
  ds_read_b64_tr_b16 v[50:51], v26 offset:29184
  v_mfma_f32_32x32x16_bf16 v[136:151], v[76:79], v[36:39], v[136:151]
  ds_read_b64_tr_b16 v[52:53], v27 offset:24576
  ds_read_b64_tr_b16 v[54:55], v27 offset:25088
  buffer_load_dwordx4 v17, s[24:27], s61 offen offset:1040 lds
  v_mfma_f32_32x32x16_bf16 v[152:167], v[80:83], v[36:39], v[152:167]
  ds_read_b64_tr_b16 v[56:57], v27 offset:26624
  ds_read_b64_tr_b16 v[58:59], v27 offset:27136
  v_mfma_f32_32x32x16_bf16 v[168:183], v[36:39], v[84:87], v[168:183]
  ds_read_b64_tr_b16 v[60:61], v27 offset:28672
  ds_read_b64_tr_b16 v[62:63], v27 offset:29184
  buffer_load_dwordx4 v18, s[24:27], s61 offen offset:2080 lds
  s_mov_b64 exec, 0xff
  buffer_load_dwordx4 v[232:235], v8, s[32:35], 0 offen sc1
  s_mov_b64 exec, -1
  s_waitcnt lgkmcnt(0)
  v_mfma_f32_32x32x16_bf16 v[88:103], v[40:43], v[32:35], v[88:103]
  ds_read_b128 v[36:39], v23 offset:16640
  ds_read_b64_tr_b16 v[64:65], v26 offset:30720
  ds_read_b64_tr_b16 v[66:67], v26 offset:31232
  v_mfma_f32_32x32x16_bf16 v[104:119], v[44:47], v[32:35], v[104:119]
  ds_read_b64_tr_b16 v[68:69], v26 offset:32768
  ds_read_b64_tr_b16 v[70:71], v26 offset:33280
  buffer_load_dwordx4 v19, s[24:27], s61 offen offset:3120 lds
  v_mfma_f32_32x32x16_bf16 v[120:135], v[32:35], v[48:51], v[120:135]
  ds_read_b64_tr_b16 v[72:73], v26 offset:34816
  ds_read_b64_tr_b16 v[74:75], v26 offset:35328
  v_mfma_f32_32x32x16_bf16 v[136:151], v[52:55], v[32:35], v[136:151]
  ds_read_b64_tr_b16 v[76:77], v27 offset:30720
  ds_read_b64_tr_b16 v[78:79], v27 offset:31232
  s_add_u32 m0, s59, 0
  s_add_u32 s63, s62, 0
  buffer_load_dwordx4 v20, s[28:31], s63 offen offset:0 lds
  v_mfma_f32_32x32x16_bf16 v[152:167], v[56:59], v[32:35], v[152:167]
  ds_read_b64_tr_b16 v[80:81], v27 offset:32768
  ds_read_b64_tr_b16 v[82:83], v27 offset:33280
  v_mfma_f32_32x32x16_bf16 v[168:183], v[32:35], v[60:63], v[168:183]
  ds_read_b64_tr_b16 v[84:85], v27 offset:34816
  ds_read_b64_tr_b16 v[86:87], v27 offset:35328
  buffer_load_dwordx4 v21, s[28:31], s63 offen offset:1024 lds
  s_waitcnt lgkmcnt(0)
  v_mfma_f32_32x32x16_bf16 v[88:103], v[64:67], v[36:39], v[88:103]
  ds_read_b128 v[32:35], v24 offset:16640
  ds_read_b64_tr_b16 v[40:41], v26 offset:36864
  ds_read_b64_tr_b16 v[42:43], v26 offset:37376
  v_mfma_f32_32x32x16_bf16 v[104:119], v[68:71], v[36:39], v[104:119]
  ds_read_b64_tr_b16 v[44:45], v26 offset:38912
  ds_read_b64_tr_b16 v[46:47], v26 offset:39424
  s_add_u32 m0, s59, 2048
  s_add_u32 s63, s62, 896
  buffer_load_dwordx4 v20, s[28:31], s63 offen offset:0 lds
  v_mfma_f32_32x32x16_bf16 v[120:135], v[36:39], v[72:75], v[120:135]
  ds_read_b64_tr_b16 v[48:49], v26 offset:40960
  ds_read_b64_tr_b16 v[50:51], v26 offset:41472
  v_mfma_f32_32x32x16_bf16 v[136:151], v[76:79], v[36:39], v[136:151]
  ds_read_b64_tr_b16 v[52:53], v27 offset:36864
  ds_read_b64_tr_b16 v[54:55], v27 offset:37376
  buffer_load_dwordx4 v21, s[28:31], s63 offen offset:1024 lds
  v_mfma_f32_32x32x16_bf16 v[152:167], v[80:83], v[36:39], v[152:167]
  ds_read_b64_tr_b16 v[56:57], v27 offset:38912
  ds_read_b64_tr_b16 v[58:59], v27 offset:39424
  v_mfma_f32_32x32x16_bf16 v[168:183], v[36:39], v[84:87], v[168:183]
  ds_read_b64_tr_b16 v[60:61], v27 offset:40960
  ds_read_b64_tr_b16 v[62:63], v27 offset:41472
  s_add_u32 m0, s59, 4096
  s_add_u32 s63, s62, 1792
  buffer_load_dwordx4 v20, s[28:31], s63 offen offset:0 lds
  s_waitcnt lgkmcnt(0)
  v_mfma_f32_32x32x16_bf16 v[88:103], v[40:43], v[32:35], v[88:103]
  ds_read_b128 v[36:39], v25 offset:16640
  ds_read_b64_tr_b16 v[64:65], v26 offset:43008
  ds_read_b64_tr_b16 v[66:67], v26 offset:43520
  v_mfma_f32_32x32x16_bf16 v[104:119], v[44:47], v[32:35], v[104:119]
  ds_read_b64_tr_b16 v[68:69], v26 offset:45056
  ds_read_b64_tr_b16 v[70:71], v26 offset:45568
  buffer_load_dwordx4 v21, s[28:31], s63 offen offset:1024 lds
  v_mfma_f32_32x32x16_bf16 v[120:135], v[32:35], v[48:51], v[120:135]
  ds_read_b64_tr_b16 v[72:73], v26 offset:47104
  ds_read_b64_tr_b16 v[74:75], v26 offset:47616
  v_mfma_f32_32x32x16_bf16 v[136:151], v[52:55], v[32:35], v[136:151]
  ds_read_b64_tr_b16 v[76:77], v27 offset:43008
  ds_read_b64_tr_b16 v[78:79], v27 offset:43520
  v_mfma_f32_32x32x16_bf16 v[152:167], v[56:59], v[32:35], v[152:167]
  ds_read_b64_tr_b16 v[80:81], v27 offset:45056
  ds_read_b64_tr_b16 v[82:83], v27 offset:45568
  v_mfma_f32_32x32x16_bf16 v[168:183], v[32:35], v[60:63], v[168:183]
  ds_read_b64_tr_b16 v[84:85], v27 offset:47104
  ds_read_b64_tr_b16 v[86:87], v27 offset:47616
  s_waitcnt vmcnt(11)
  s_waitcnt lgkmcnt(0)
  s_barrier
  v_mfma_f32_32x32x16_bf16 v[88:103], v[64:67], v[36:39], v[88:103]
  ds_read_b128 v[32:35], v22 offset:33280
  ds_read_b64_tr_b16 v[40:41], v28 offset:0
  ds_read_b64_tr_b16 v[42:43], v28 offset:512
  v_mfma_f32_32x32x16_bf16 v[104:119], v[68:71], v[36:39], v[104:119]
  ds_read_b64_tr_b16 v[44:45], v28 offset:2048
  ds_read_b64_tr_b16 v[46:47], v28 offset:2560
  v_mfma_f32_32x32x16_bf16 v[120:135], v[36:39], v[72:75], v[120:135]
  ds_read_b64_tr_b16 v[48:49], v28 offset:4096
  ds_read_b64_tr_b16 v[50:51], v28 offset:4608
  v_mfma_f32_32x32x16_bf16 v[136:151], v[76:79], v[36:39], v[136:151]
  ds_read_b64_tr_b16 v[52:53], v29 offset:0
  ds_read_b64_tr_b16 v[54:55], v29 offset:512
  v_mfma_f32_32x32x16_bf16 v[152:167], v[80:83], v[36:39], v[152:167]
  ds_read_b64_tr_b16 v[56:57], v29 offset:2048
  ds_read_b64_tr_b16 v[58:59], v29 offset:2560
  v_mfma_f32_32x32x16_bf16 v[168:183], v[36:39], v[84:87], v[168:183]
  ds_read_b64_tr_b16 v[60:61], v29 offset:4096
  ds_read_b64_tr_b16 v[62:63], v29 offset:4608
  s_lshr_b32 s52, s2, 3
  s_lshl_b32 s52, s52, 2
  s_add_u32 s52, s52, s48
  s_mul_i32 s53, s52, 3200
  v_lshlrev_b32 v3, 7, v1
  s_mov_b64 exec, 0x1ffffff
  buffer_load_dword v232, v3, s[44:47], s53 offen
  buffer_load_dword v233, v3, s[40:43], s53 offen
  s_getpc_b64 s[76:77]
L_pc_anchor:
  s_sub_u32 s76, s76, L_pc_anchor-concat_heads__sliding_block__softmax_full_mha__prompt_kernel
  s_subb_u32 s77, s77, 0
  s_mul_i32 s53, s52, 384
  v_add_u32 v4, s53, v3
  v_min_u32 v4, L_end-concat_heads__sliding_block__softmax_full_mha__prompt_kernel, v4
  s_mov_b64 exec, 7
  global_load_dword v234, v4, s[76:77]
  v_lshlrev_b32 v4, 21, v1
  s_mov_b64 exec, 0x1ff
  buffer_load_dword v235, v4, s[32:35], 0 offen
  s_mov_b64 exec, 3
  buffer_load_dword v236, v4, s[36:39], 0 offen
  s_mov_b64 exec, -1
  s_waitcnt lgkmcnt(0)
  v_mfma_f32_32x32x16_bf16 v[88:103], v[40:43], v[32:35], v[88:103]
  ds_read_b128 v[36:39], v23 offset:33280
  ds_read_b64_tr_b16 v[64:65], v28 offset:6144
  ds_read_b64_tr_b16 v[66:67], v28 offset:6656
  v_mfma_f32_32x32x16_bf16 v[104:119], v[44:47], v[32:35], v[104:119]
  ds_read_b64_tr_b16 v[68:69], v28 offset:8192
  ds_read_b64_tr_b16 v[70:71], v28 offset:8704
  v_mfma_f32_32x32x16_bf16 v[120:135], v[32:35], v[48:51], v[120:135]
  ds_read_b64_tr_b16 v[72:73], v28 offset:10240
  ds_read_b64_tr_b16 v[74:75], v28 offset:10752
  v_mfma_f32_32x32x16_bf16 v[136:151], v[52:55], v[32:35], v[136:151]
  ds_read_b64_tr_b16 v[76:77], v29 offset:6144
  ds_read_b64_tr_b16 v[78:79], v29 offset:6656
  v_mfma_f32_32x32x16_bf16 v[152:167], v[56:59], v[32:35], v[152:167]
  ds_read_b64_tr_b16 v[80:81], v29 offset:8192
  ds_read_b64_tr_b16 v[82:83], v29 offset:8704
  v_mfma_f32_32x32x16_bf16 v[168:183], v[32:35], v[60:63], v[168:183]
  ds_read_b64_tr_b16 v[84:85], v29 offset:10240
  ds_read_b64_tr_b16 v[86:87], v29 offset:10752
  s_waitcnt lgkmcnt(0)
  v_mfma_f32_32x32x16_bf16 v[88:103], v[64:67], v[36:39], v[88:103]
  ds_read_b128 v[32:35], v24 offset:33280
  ds_read_b64_tr_b16 v[40:41], v28 offset:12288
  ds_read_b64_tr_b16 v[42:43], v28 offset:12800
  v_mfma_f32_32x32x16_bf16 v[104:119], v[68:71], v[36:39], v[104:119]
  ds_read_b64_tr_b16 v[44:45], v28 offset:14336
  ds_read_b64_tr_b16 v[46:47], v28 offset:14848
  v_mfma_f32_32x32x16_bf16 v[120:135], v[36:39], v[72:75], v[120:135]
  ds_read_b64_tr_b16 v[48:49], v28 offset:16384
  ds_read_b64_tr_b16 v[50:51], v28 offset:16896
  v_mfma_f32_32x32x16_bf16 v[136:151], v[76:79], v[36:39], v[136:151]
  ds_read_b64_tr_b16 v[52:53], v29 offset:12288
  ds_read_b64_tr_b16 v[54:55], v29 offset:12800
  v_mfma_f32_32x32x16_bf16 v[152:167], v[80:83], v[36:39], v[152:167]
  ds_read_b64_tr_b16 v[56:57], v29 offset:14336
  ds_read_b64_tr_b16 v[58:59], v29 offset:14848
  v_mfma_f32_32x32x16_bf16 v[168:183], v[36:39], v[84:87], v[168:183]
  ds_read_b64_tr_b16 v[60:61], v29 offset:16384
  ds_read_b64_tr_b16 v[62:63], v29 offset:16896
  s_waitcnt lgkmcnt(0)
  v_mfma_f32_32x32x16_bf16 v[88:103], v[40:43], v[32:35], v[88:103]
  ds_read_b128 v[36:39], v25 offset:33280
  ds_read_b64_tr_b16 v[64:65], v28 offset:18432
  ds_read_b64_tr_b16 v[66:67], v28 offset:18944
  v_mfma_f32_32x32x16_bf16 v[104:119], v[44:47], v[32:35], v[104:119]
  ds_read_b64_tr_b16 v[68:69], v28 offset:20480
  ds_read_b64_tr_b16 v[70:71], v28 offset:20992
  v_mfma_f32_32x32x16_bf16 v[120:135], v[32:35], v[48:51], v[120:135]
  ds_read_b64_tr_b16 v[72:73], v28 offset:22528
  ds_read_b64_tr_b16 v[74:75], v28 offset:23040
  v_mfma_f32_32x32x16_bf16 v[136:151], v[52:55], v[32:35], v[136:151]
  ds_read_b64_tr_b16 v[76:77], v29 offset:18432
  ds_read_b64_tr_b16 v[78:79], v29 offset:18944
  v_mfma_f32_32x32x16_bf16 v[152:167], v[56:59], v[32:35], v[152:167]
  ds_read_b64_tr_b16 v[80:81], v29 offset:20480
  ds_read_b64_tr_b16 v[82:83], v29 offset:20992
  v_mfma_f32_32x32x16_bf16 v[168:183], v[32:35], v[60:63], v[168:183]
  ds_read_b64_tr_b16 v[84:85], v29 offset:22528
  ds_read_b64_tr_b16 v[86:87], v29 offset:23040
  s_waitcnt vmcnt(5)
  s_waitcnt lgkmcnt(0)
  s_barrier
  v_mfma_f32_32x32x16_bf16 v[88:103], v[64:67], v[36:39], v[88:103]
  ds_read_b128 v[32:35], v22 offset:0
  ds_read_b64_tr_b16 v[40:41], v26 offset:0
  ds_read_b64_tr_b16 v[42:43], v26 offset:512
  v_mfma_f32_32x32x16_bf16 v[104:119], v[68:71], v[36:39], v[104:119]
  ds_read_b64_tr_b16 v[44:45], v26 offset:2048
  ds_read_b64_tr_b16 v[46:47], v26 offset:2560
  v_mfma_f32_32x32x16_bf16 v[120:135], v[36:39], v[72:75], v[120:135]
  ds_read_b64_tr_b16 v[48:49], v26 offset:4096
  ds_read_b64_tr_b16 v[50:51], v26 offset:4608
  v_mfma_f32_32x32x16_bf16 v[136:151], v[76:79], v[36:39], v[136:151]
  ds_read_b64_tr_b16 v[52:53], v27 offset:0
  ds_read_b64_tr_b16 v[54:55], v27 offset:512
  v_mfma_f32_32x32x16_bf16 v[152:167], v[80:83], v[36:39], v[152:167]
  ds_read_b64_tr_b16 v[56:57], v27 offset:2048
  ds_read_b64_tr_b16 v[58:59], v27 offset:2560
  v_mfma_f32_32x32x16_bf16 v[168:183], v[36:39], v[84:87], v[168:183]
  ds_read_b64_tr_b16 v[60:61], v27 offset:4096
  ds_read_b64_tr_b16 v[62:63], v27 offset:4608
  s_mov_b64 exec, 0xffffffff
  buffer_load_dword v6, v11, s[32:35], 0 offen sc1
  s_mov_b64 exec, -1
  s_waitcnt lgkmcnt(0)
  v_mfma_f32_32x32x16_bf16 v[88:103], v[40:43], v[32:35], v[88:103]
  ds_read_b128 v[36:39], v23 offset:0
  ds_read_b64_tr_b16 v[64:65], v26 offset:6144
  ds_read_b64_tr_b16 v[66:67], v26 offset:6656
  v_mfma_f32_32x32x16_bf16 v[104:119], v[44:47], v[32:35], v[104:119]
  ds_read_b64_tr_b16 v[68:69], v26 offset:8192
  ds_read_b64_tr_b16 v[70:71], v26 offset:8704
  v_mfma_f32_32x32x16_bf16 v[120:135], v[32:35], v[48:51], v[120:135]
  ds_read_b64_tr_b16 v[72:73], v26 offset:10240
  ds_read_b64_tr_b16 v[74:75], v26 offset:10752
  v_mfma_f32_32x32x16_bf16 v[136:151], v[52:55], v[32:35], v[136:151]
  ds_read_b64_tr_b16 v[76:77], v27 offset:6144
  ds_read_b64_tr_b16 v[78:79], v27 offset:6656
  v_mfma_f32_32x32x16_bf16 v[152:167], v[56:59], v[32:35], v[152:167]
  ds_read_b64_tr_b16 v[80:81], v27 offset:8192
  ds_read_b64_tr_b16 v[82:83], v27 offset:8704
  v_mfma_f32_32x32x16_bf16 v[168:183], v[32:35], v[60:63], v[168:183]
  ds_read_b64_tr_b16 v[84:85], v27 offset:10240
  ds_read_b64_tr_b16 v[86:87], v27 offset:10752
  s_waitcnt lgkmcnt(0)
  v_mfma_f32_32x32x16_bf16 v[88:103], v[64:67], v[36:39], v[88:103]
  ds_read_b128 v[32:35], v24 offset:0
  ds_read_b64_tr_b16 v[40:41], v26 offset:12288
  ds_read_b64_tr_b16 v[42:43], v26 offset:12800
  v_mfma_f32_32x32x16_bf16 v[104:119], v[68:71], v[36:39], v[104:119]
  ds_read_b64_tr_b16 v[44:45], v26 offset:14336
  ds_read_b64_tr_b16 v[46:47], v26 offset:14848
  v_mfma_f32_32x32x16_bf16 v[120:135], v[36:39], v[72:75], v[120:135]
  ds_read_b64_tr_b16 v[48:49], v26 offset:16384
  ds_read_b64_tr_b16 v[50:51], v26 offset:16896
  v_mfma_f32_32x32x16_bf16 v[136:151], v[76:79], v[36:39], v[136:151]
  ds_read_b64_tr_b16 v[52:53], v27 offset:12288
  ds_read_b64_tr_b16 v[54:55], v27 offset:12800
  v_mfma_f32_32x32x16_bf16 v[152:167], v[80:83], v[36:39], v[152:167]
  ds_read_b64_tr_b16 v[56:57], v27 offset:14336
  ds_read_b64_tr_b16 v[58:59], v27 offset:14848
  v_mfma_f32_32x32x16_bf16 v[168:183], v[36:39], v[84:87], v[168:183]
  ds_read_b64_tr_b16 v[60:61], v27 offset:16384
  ds_read_b64_tr_b16 v[62:63], v27 offset:16896
  s_waitcnt lgkmcnt(0)
  v_mfma_f32_32x32x16_bf16 v[88:103], v[40:43], v[32:35], v[88:103]
  ds_read_b128 v[36:39], v25 offset:0
  ds_read_b64_tr_b16 v[64:65], v26 offset:18432
  ds_read_b64_tr_b16 v[66:67], v26 offset:18944
  v_mfma_f32_32x32x16_bf16 v[104:119], v[44:47], v[32:35], v[104:119]
  ds_read_b64_tr_b16 v[68:69], v26 offset:20480
  ds_read_b64_tr_b16 v[70:71], v26 offset:20992
  v_mfma_f32_32x32x16_bf16 v[120:135], v[32:35], v[48:51], v[120:135]
  ds_read_b64_tr_b16 v[72:73], v26 offset:22528
  ds_read_b64_tr_b16 v[74:75], v26 offset:23040
  v_mfma_f32_32x32x16_bf16 v[136:151], v[52:55], v[32:35], v[136:151]
  ds_read_b64_tr_b16 v[76:77], v27 offset:18432
  ds_read_b64_tr_b16 v[78:79], v27 offset:18944
  v_mfma_f32_32x32x16_bf16 v[152:167], v[56:59], v[32:35], v[152:167]
  ds_read_b64_tr_b16 v[80:81], v27 offset:20480
  ds_read_b64_tr_b16 v[82:83], v27 offset:20992
  v_mfma_f32_32x32x16_bf16 v[168:183], v[32:35], v[60:63], v[168:183]
  ds_read_b64_tr_b16 v[84:85], v27 offset:22528
  ds_read_b64_tr_b16 v[86:87], v27 offset:23040
  s_waitcnt lgkmcnt(0)
  v_mfma_f32_32x32x16_bf16 v[88:103], v[64:67], v[36:39], v[88:103]
  v_mfma_f32_32x32x16_bf16 v[104:119], v[68:71], v[36:39], v[104:119]
  v_mfma_f32_32x32x16_bf16 v[120:135], v[36:39], v[72:75], v[120:135]
  v_mfma_f32_32x32x16_bf16 v[136:151], v[76:79], v[36:39], v[136:151]
  v_mfma_f32_32x32x16_bf16 v[152:167], v[80:83], v[36:39], v[152:167]
  v_mfma_f32_32x32x16_bf16 v[168:183], v[36:39], v[84:87], v[168:183]
  s_mov_b32 s92, 0x3e8b97f6
  s_nop 1
  s_waitcnt vmcnt(0)
  s_mov_b64 exec, 0xffffffff
  v_cmp_ne_u32 vcc, s95, v6
  s_mov_b64 exec, -1
  s_cmp_eq_u64 vcc, 0
  s_cselect_b32 s95, 1, 0
  s_lshl_b32 s52, s49, 3
  s_add_u32 s52, s52, s50
  s_lshl_b32 s52, s52, 4
  s_add_u32 s52, s52, s51
  s_lshl_b32 s52, s52, 7
  s_lshl_b32 s53, s48, 2
  s_add_u32 s52, s52, s53
  s_add_u32 s85, s52, 16777216
  s_cmp_eq_u32 s49, 1
  s_cselect_b32 s52, 1.0, 0
  v_pk_mul_f32 v[40:41], v[240:241], s[52:53] op_sel_hi:[1,0]
  v_pk_mul_f32 v[42:43], v[242:243], s[52:53] op_sel_hi:[1,0]
  v_pk_mul_f32 v[44:45], v[244:245], s[52:53] op_sel_hi:[1,0]
  v_pk_mul_f32 v[46:47], v[246:247], s[52:53] op_sel_hi:[1,0]
  v_pk_mul_f32 v[48:49], v[248:249], s[52:53] op_sel_hi:[1,0]
  v_pk_mul_f32 v[50:51], v[250:251], s[52:53] op_sel_hi:[1,0]
  v_pk_mul_f32 v[52:53], v[252:253], s[52:53] op_sel_hi:[1,0]
  v_pk_mul_f32 v[54:55], v[254:255], s[52:53] op_sel_hi:[1,0]
  s_cmp_eq_u32 s95, 0
  s_cbranch_scc1 L_slow_5
  s_cmp_eq_u32 s49, 1
  s_cbranch_scc1 L_ant_7
  v_cvt_pk_bf16_f32 v184, v104, v105
  v_cvt_pk_bf16_f32 v185, v106, v107
  v_cvt_pk_bf16_f32 v186, v108, v109
  v_cvt_pk_bf16_f32 v187, v110, v111
  v_cvt_pk_bf16_f32 v188, v112, v113
  v_cvt_pk_bf16_f32 v189, v114, v115
  v_cvt_pk_bf16_f32 v190, v116, v117
  v_cvt_pk_bf16_f32 v191, v118, v119
  v_pk_mul_f32 v[88:89], v[88:89], s[92:93] op_sel_hi:[1,0]
  v_pk_mul_f32 v[90:91], v[90:91], s[92:93] op_sel_hi:[1,0]
  v_pk_mul_f32 v[92:93], v[92:93], s[92:93] op_sel_hi:[1,0]
  v_pk_mul_f32 v[94:95], v[94:95], s[92:93] op_sel_hi:[1,0]
  v_pk_mul_f32 v[96:97], v[96:97], s[92:93] op_sel_hi:[1,0]
  v_pk_mul_f32 v[98:99], v[98:99], s[92:93] op_sel_hi:[1,0]
  v_pk_mul_f32 v[100:101], v[100:101], s[92:93] op_sel_hi:[1,0]
  v_pk_mul_f32 v[102:103], v[102:103], s[92:93] op_sel_hi:[1,0]
  v_cvt_pk_bf16_f32 v200, v88, v89
  v_cvt_pk_bf16_f32 v201, v90, v91
  v_cvt_pk_bf16_f32 v202, v92, v93
  v_cvt_pk_bf16_f32 v203, v94, v95
  v_cvt_pk_bf16_f32 v204, v96, v97
  v_cvt_pk_bf16_f32 v205, v98, v99
  v_cvt_pk_bf16_f32 v206, v100, v101
  v_cvt_pk_bf16_f32 v207, v102, v103
  s_mov_b32 exec_lo, 0
  v_mov_b32 v190, 0x3f803f80
  v_mov_b32 v191, 0x00003f80
  v_mov_b32 v206, 0
  v_mov_b32 v207, 0
  s_mov_b32 exec_lo, -1
  buffer_store_dwordx4 v[184:187], v2, s[32:35], s0 offen sc1
  buffer_store_dwordx4 v[188:191], v2, s[32:35], s0 offen offset:1024 sc1
  v_mfma_f32_32x32x16_bf16 v[104:119], v[184:187], v[200:203], v[40:55]
  v_mfma_f32_32x32x16_bf16 v[104:119], v[188:191], v[204:207], v[104:119]
  v_cvt_pk_bf16_f32 v208, v152, v153
  v_cvt_pk_bf16_f32 v209, v154, v155
  v_cvt_pk_bf16_f32 v210, v156, v157
  v_cvt_pk_bf16_f32 v211, v158, v159
  v_cvt_pk_bf16_f32 v212, v160, v161
  v_cvt_pk_bf16_f32 v213, v162, v163
  v_cvt_pk_bf16_f32 v214, v164, v165
  v_cvt_pk_bf16_f32 v215, v166, v167
  v_pk_mul_f32 v[136:137], v[136:137], s[92:93] op_sel_hi:[1,0]
  v_pk_mul_f32 v[138:139], v[138:139], s[92:93] op_sel_hi:[1,0]
  v_pk_mul_f32 v[140:141], v[140:141], s[92:93] op_sel_hi:[1,0]
  v_pk_mul_f32 v[142:143], v[142:143], s[92:93] op_sel_hi:[1,0]
  v_pk_mul_f32 v[144:145], v[144:145], s[92:93] op_sel_hi:[1,0]
  v_pk_mul_f32 v[146:147], v[146:147], s[92:93] op_sel_hi:[1,0]
  v_pk_mul_f32 v[148:149], v[148:149], s[92:93] op_sel_hi:[1,0]
  v_pk_mul_f32 v[150:151], v[150:151], s[92:93] op_sel_hi:[1,0]
  v_cvt_pk_bf16_f32 v224, v136, v137
  v_cvt_pk_bf16_f32 v225, v138, v139
  v_cvt_pk_bf16_f32 v226, v140, v141
  v_cvt_pk_bf16_f32 v227, v142, v143
  v_cvt_pk_bf16_f32 v228, v144, v145
  v_cvt_pk_bf16_f32 v229, v146, v147
  v_cvt_pk_bf16_f32 v230, v148, v149
  v_cvt_pk_bf16_f32 v231, v150, v151
  s_mov_b32 exec_lo, 0
  v_mov_b32 v214, 0x3f803f80
  v_mov_b32 v215, 0x00003f80
  v_mov_b32 v230, 0
  v_mov_b32 v231, 0
  s_mov_b32 exec_lo, -1
  buffer_store_dwordx4 v[208:211], v2, s[32:35], s22 offen sc1
  buffer_store_dwordx4 v[212:215], v2, s[32:35], s22 offen offset:1024 sc1
  v_mfma_f32_32x32x16_bf16 v[152:167], v[208:211], v[224:227], v[40:55]
  v_mfma_f32_32x32x16_bf16 v[152:167], v[212:215], v[228:231], v[152:167]
  v_cvt_pk_bf16_f32 v192, v120, v121
  v_cvt_pk_bf16_f32 v193, v122, v123
  v_cvt_pk_bf16_f32 v194, v124, v125
  v_cvt_pk_bf16_f32 v195, v126, v127
  v_cvt_pk_bf16_f32 v196, v128, v129
  v_cvt_pk_bf16_f32 v197, v130, v131
  v_cvt_pk_bf16_f32 v198, v132, v133
  v_cvt_pk_bf16_f32 v199, v134, v135
  v_cndmask_b32_e64 v192, v192, v10, s[64:65]
  v_cndmask_b32_e64 v193, v193, v10, s[64:65]
  v_cndmask_b32_e64 v194, v194, v10, s[64:65]
  v_cndmask_b32_e64 v195, v195, v10, s[64:65]
  v_cndmask_b32_e64 v196, v196, v10, s[64:65]
  v_cndmask_b32_e64 v197, v197, v10, s[64:65]
  v_cndmask_b32_e64 v198, v198, v10, s[64:65]
  v_cndmask_b32_e64 v199, v199, v10, s[64:65]
  buffer_store_dwordx4 v[192:195], v2, s[32:35], s1 offen sc1
  buffer_store_dwordx4 v[196:199], v2, s[32:35], s1 offen offset:1024 sc1
  v_cvt_pk_bf16_f32 v216, v168, v169
  v_cvt_pk_bf16_f32 v217, v170, v171
  v_cvt_pk_bf16_f32 v218, v172, v173
  v_cvt_pk_bf16_f32 v219, v174, v175
  v_cvt_pk_bf16_f32 v220, v176, v177
  v_cvt_pk_bf16_f32 v221, v178, v179
  v_cvt_pk_bf16_f32 v222, v180, v181
  v_cvt_pk_bf16_f32 v223, v182, v183
  v_cndmask_b32_e64 v216, v216, v10, s[64:65]
  v_cndmask_b32_e64 v217, v217, v10, s[64:65]
  v_cndmask_b32_e64 v218, v218, v10, s[64:65]
  v_cndmask_b32_e64 v219, v219, v10, s[64:65]
  v_cndmask_b32_e64 v220, v220, v10, s[64:65]
  v_cndmask_b32_e64 v221, v221, v10, s[64:65]
  v_cndmask_b32_e64 v222, v222, v10, s[64:65]
  v_cndmask_b32_e64 v223, v223, v10, s[64:65]
  buffer_store_dwordx4 v[216:219], v2, s[32:35], s23 offen sc1
  buffer_store_dwordx4 v[220:223], v2, s[32:35], s23 offen offset:1024 sc1
  v_max3_f32 v6, v104, v105, v106
  v_max3_f32 v3, v107, v108, v109
  v_max3_f32 v6, v6, v110, v111
  v_max3_f32 v3, v3, v112, v113
  v_max3_f32 v6, v6, v114, v115
  v_max3_f32 v3, v3, v116, v117
  v_max3_f32 v6, v6, v118, v119
  v_max_f32 v6, v6, v3
  v_mov_b32 v3, v6
  s_nop 1
  v_permlane32_swap_b32 v6, v3
  v_max_f32 v6, v6, v3
  v_add_f32 v6, 0x42800000, v6
  v_and_b32 v3, 0xffff0000, v6
  v_sub_f32 v4, v6, v3
  v_and_b32 v5, 0xffff0000, v4
  v_sub_f32 v4, v4, v5
  v_lshrrev_b32 v3, 16, v3
  v_or_b32 v3, v3, v5
  v_xor_b32 v3, 0x80008000, v3
  v_lshrrev_b32 v4, 16, v4
  v_xor_b32 v4, 0x8000, v4
  s_mov_b32 exec_lo, 0
  v_mov_b32 v206, v3
  v_mov_b32 v207, v4
  s_mov_b32 exec_lo, -1
  buffer_store_dwordx4 v[200:203], v2, s[32:35], s3 offen sc1
  buffer_store_dwordx4 v[204:207], v2, s[32:35], s3 offen offset:1024 sc1
  v_max3_f32 v6, v152, v153, v154
  v_max3_f32 v3, v155, v156, v157
  v_max3_f32 v6, v6, v158, v159
  v_max3_f32 v3, v3, v160, v161
  v_max3_f32 v6, v6, v162, v163
  v_max3_f32 v3, v3, v164, v165
  v_max3_f32 v6, v6, v166, v167
  v_max_f32 v6, v6, v3
  v_mov_b32 v3, v6
  s_nop 1
  v_permlane32_swap_b32 v6, v3
  v_max_f32 v6, v6, v3
  v_add_f32 v6, 0x42800000, v6
  v_and_b32 v3, 0xffff0000, v6
  v_sub_f32 v4, v6, v3
  v_and_b32 v5, 0xffff0000, v4
  v_sub_f32 v4, v4, v5
  v_lshrrev_b32 v3, 16, v3
  v_or_b32 v3, v3, v5
  v_xor_b32 v3, 0x80008000, v3
  v_lshrrev_b32 v4, 16, v4
  v_xor_b32 v4, 0x8000, v4
  s_mov_b32 exec_lo, 0
  v_mov_b32 v230, v3
  v_mov_b32 v231, v4
  s_mov_b32 exec_lo, -1
  buffer_store_dwordx4 v[224:227], v2, s[32:35], s101 offen sc1
  buffer_store_dwordx4 v[228:231], v2, s[32:35], s101 offen offset:1024 sc1
  v_mov_b32 v3, 0
  v_mov_b32 v4, s66
  s_waitcnt vmcnt(0)
  s_mov_b64 exec, 1
  buffer_store_dword v4, v3, s[32:35], s85 offen
  s_mov_b64 exec, -1
  s_branch L_stored_6
L_ant_7:
  v_cvt_pk_bf16_f32 v184, v104, v105
  v_cvt_pk_bf16_f32 v185, v106, v107
  v_cvt_pk_bf16_f32 v186, v108, v109
  v_cvt_pk_bf16_f32 v187, v110, v111
  v_cvt_pk_bf16_f32 v188, v112, v113
  v_cvt_pk_bf16_f32 v189, v114, v115
  v_cvt_pk_bf16_f32 v190, v116, v117
  v_cvt_pk_bf16_f32 v191, v118, v119
  v_pk_mul_f32 v[88:89], v[88:89], s[92:93] op_sel_hi:[1,0]
  v_pk_mul_f32 v[90:91], v[90:91], s[92:93] op_sel_hi:[1,0]
  v_pk_mul_f32 v[92:93], v[92:93], s[92:93] op_sel_hi:[1,0]
  v_pk_mul_f32 v[94:95], v[94:95], s[92:93] op_sel_hi:[1,0]
  v_pk_mul_f32 v[96:97], v[96:97], s[92:93] op_sel_hi:[1,0]
  v_pk_mul_f32 v[98:99], v[98:99], s[92:93] op_sel_hi:[1,0]
  v_pk_mul_f32 v[100:101], v[100:101], s[92:93] op_sel_hi:[1,0]
  v_pk_mul_f32 v[102:103], v[102:103], s[92:93] op_sel_hi:[1,0]
  v_cvt_pk_bf16_f32 v200, v88, v89
  v_cvt_pk_bf16_f32 v201, v90, v91
  v_cvt_pk_bf16_f32 v202, v92, v93
  v_cvt_pk_bf16_f32 v203, v94, v95
  v_cvt_pk_bf16_f32 v204, v96, v97
  v_cvt_pk_bf16_f32 v205, v98, v99
  v_cvt_pk_bf16_f32 v206, v100, v101
  v_cvt_pk_bf16_f32 v207, v102, v103
  s_mov_b32 exec_lo, 0
  v_mov_b32 v190, 0x3f803f80
  v_mov_b32 v191, 0x00003f80
  v_mov_b32 v206, 0
  v_mov_b32 v207, 0
  s_mov_b32 exec_lo, -1
  buffer_store_dwordx4 v[184:187], v2, s[32:35], s0 offen sc1
  buffer_store_dwordx4 v[188:191], v2, s[32:35], s0 offen offset:1024 sc1
  v_mfma_f32_32x32x16_bf16 v[104:119], v[184:187], v[200:203], v[40:55]
  v_mfma_f32_32x32x16_bf16 v[104:119], v[188:191], v[204:207], v[104:119]
  v_cvt_pk_bf16_f32 v208, v152, v153
  v_cvt_pk_bf16_f32 v209, v154, v155
  v_cvt_pk_bf16_f32 v210, v156, v157
  v_cvt_pk_bf16_f32 v211, v158, v159
  v_cvt_pk_bf16_f32 v212, v160, v161
  v_cvt_pk_bf16_f32 v213, v162, v163
  v_cvt_pk_bf16_f32 v214, v164, v165
  v_cvt_pk_bf16_f32 v215, v166, v167
  v_pk_mul_f32 v[136:137], v[136:137], s[92:93] op_sel_hi:[1,0]
  v_pk_mul_f32 v[138:139], v[138:139], s[92:93] op_sel_hi:[1,0]
  v_pk_mul_f32 v[140:141], v[140:141], s[92:93] op_sel_hi:[1,0]
  v_pk_mul_f32 v[142:143], v[142:143], s[92:93] op_sel_hi:[1,0]
  v_pk_mul_f32 v[144:145], v[144:145], s[92:93] op_sel_hi:[1,0]
  v_pk_mul_f32 v[146:147], v[146:147], s[92:93] op_sel_hi:[1,0]
  v_pk_mul_f32 v[148:149], v[148:149], s[92:93] op_sel_hi:[1,0]
  v_pk_mul_f32 v[150:151], v[150:151], s[92:93] op_sel_hi:[1,0]
  v_cvt_pk_bf16_f32 v224, v136, v137
  v_cvt_pk_bf16_f32 v225, v138, v139
  v_cvt_pk_bf16_f32 v226, v140, v141
  v_cvt_pk_bf16_f32 v227, v142, v143
  v_cvt_pk_bf16_f32 v228, v144, v145
  v_cvt_pk_bf16_f32 v229, v146, v147
  v_cvt_pk_bf16_f32 v230, v148, v149
  v_cvt_pk_bf16_f32 v231, v150, v151
  s_mov_b32 exec_lo, 0
  v_mov_b32 v214, 0x3f803f80
  v_mov_b32 v215, 0x00003f80
  v_mov_b32 v230, 0
  v_mov_b32 v231, 0
  s_mov_b32 exec_lo, -1
  buffer_store_dwordx4 v[208:211], v2, s[32:35], s22 offen sc1
  buffer_store_dwordx4 v[212:215], v2, s[32:35], s22 offen offset:1024 sc1
  v_mfma_f32_32x32x16_bf16 v[152:167], v[208:211], v[224:227], v[40:55]
  v_mfma_f32_32x32x16_bf16 v[152:167], v[212:215], v[228:231], v[152:167]
  v_cvt_pk_bf16_f32 v192, v120, v121
  v_cvt_pk_bf16_f32 v193, v122, v123
  v_cvt_pk_bf16_f32 v194, v124, v125
  v_cvt_pk_bf16_f32 v195, v126, v127
  v_cvt_pk_bf16_f32 v196, v128, v129
  v_cvt_pk_bf16_f32 v197, v130, v131
  v_cvt_pk_bf16_f32 v198, v132, v133
  v_cvt_pk_bf16_f32 v199, v134, v135
  v_cndmask_b32_e64 v192, v192, v10, s[64:65]
  v_cndmask_b32_e64 v193, v193, v10, s[64:65]
  v_cndmask_b32_e64 v194, v194, v10, s[64:65]
  v_cndmask_b32_e64 v195, v195, v10, s[64:65]
  v_cndmask_b32_e64 v196, v196, v10, s[64:65]
  v_cndmask_b32_e64 v197, v197, v10, s[64:65]
  v_cndmask_b32_e64 v198, v198, v10, s[64:65]
  v_cndmask_b32_e64 v199, v199, v10, s[64:65]
  buffer_store_dwordx4 v[192:195], v2, s[32:35], s1 offen sc1
  buffer_store_dwordx4 v[196:199], v2, s[32:35], s1 offen offset:1024 sc1
  v_cvt_pk_bf16_f32 v216, v168, v169
  v_cvt_pk_bf16_f32 v217, v170, v171
  v_cvt_pk_bf16_f32 v218, v172, v173
  v_cvt_pk_bf16_f32 v219, v174, v175
  v_cvt_pk_bf16_f32 v220, v176, v177
  v_cvt_pk_bf16_f32 v221, v178, v179
  v_cvt_pk_bf16_f32 v222, v180, v181
  v_cvt_pk_bf16_f32 v223, v182, v183
  v_cndmask_b32_e64 v216, v216, v10, s[64:65]
  v_cndmask_b32_e64 v217, v217, v10, s[64:65]
  v_cndmask_b32_e64 v218, v218, v10, s[64:65]
  v_cndmask_b32_e64 v219, v219, v10, s[64:65]
  v_cndmask_b32_e64 v220, v220, v10, s[64:65]
  v_cndmask_b32_e64 v221, v221, v10, s[64:65]
  v_cndmask_b32_e64 v222, v222, v10, s[64:65]
  v_cndmask_b32_e64 v223, v223, v10, s[64:65]
  buffer_store_dwordx4 v[216:219], v2, s[32:35], s23 offen sc1
  buffer_store_dwordx4 v[220:223], v2, s[32:35], s23 offen offset:1024 sc1
  v_max3_f32 v6, v104, v105, v106
  v_max3_f32 v3, v107, v108, v109
  v_max3_f32 v6, v6, v110, v111
  v_max3_f32 v3, v3, v112, v113
  v_max3_f32 v6, v6, v114, v115
  v_max3_f32 v3, v3, v116, v117
  v_max3_f32 v6, v6, v118, v119
  v_max_f32 v6, v6, v3
  v_mov_b32 v3, v6
  s_nop 1
  v_permlane32_swap_b32 v6, v3
  v_max_f32 v6, v6, v3
  v_add_f32 v6, 0x42800000, v6
  v_and_b32 v3, 0xffff0000, v6
  v_sub_f32 v4, v6, v3
  v_and_b32 v5, 0xffff0000, v4
  v_sub_f32 v4, v4, v5
  v_lshrrev_b32 v3, 16, v3
  v_or_b32 v3, v3, v5
  v_xor_b32 v3, 0x80008000, v3
  v_lshrrev_b32 v4, 16, v4
  v_xor_b32 v4, 0x8000, v4
  s_mov_b32 exec_lo, 0
  v_mov_b32 v206, v3
  v_mov_b32 v207, v4
  s_mov_b32 exec_lo, -1
  buffer_store_dwordx4 v[200:203], v2, s[32:35], s3 offen sc1
  buffer_store_dwordx4 v[204:207], v2, s[32:35], s3 offen offset:1024 sc1
  v_max3_f32 v6, v152, v153, v154
  v_max3_f32 v3, v155, v156, v157
  v_max3_f32 v6, v6, v158, v159
  v_max3_f32 v3, v3, v160, v161
  v_max3_f32 v6, v6, v162, v163
  v_max3_f32 v3, v3, v164, v165
  v_max3_f32 v6, v6, v166, v167
  v_max_f32 v6, v6, v3
  v_mov_b32 v3, v6
  s_nop 1
  v_permlane32_swap_b32 v6, v3
  v_max_f32 v6, v6, v3
  v_add_f32 v6, 0x42800000, v6
  v_and_b32 v3, 0xffff0000, v6
  v_sub_f32 v4, v6, v3
  v_and_b32 v5, 0xffff0000, v4
  v_sub_f32 v4, v4, v5
  v_lshrrev_b32 v3, 16, v3
  v_or_b32 v3, v3, v5
  v_xor_b32 v3, 0x80008000, v3
  v_lshrrev_b32 v4, 16, v4
  v_xor_b32 v4, 0x8000, v4
  s_mov_b32 exec_lo, 0
  v_mov_b32 v230, v3
  v_mov_b32 v231, v4
  s_mov_b32 exec_lo, -1
  buffer_store_dwordx4 v[224:227], v2, s[32:35], s101 offen sc1
  buffer_store_dwordx4 v[228:231], v2, s[32:35], s101 offen offset:1024 sc1
  v_mov_b32 v3, 0
  v_mov_b32 v4, s66
  s_waitcnt vmcnt(0)
  s_mov_b64 exec, 1
  buffer_store_dword v4, v3, s[32:35], s85 offen
  s_mov_b64 exec, -1
  s_branch L_stored_6
L_slow_5:
  v_cvt_pk_bf16_f32 v184, v104, v105
  v_cvt_pk_bf16_f32 v185, v106, v107
  v_cvt_pk_bf16_f32 v186, v108, v109
  v_cvt_pk_bf16_f32 v187, v110, v111
  v_cvt_pk_bf16_f32 v188, v112, v113
  v_cvt_pk_bf16_f32 v189, v114, v115
  v_cvt_pk_bf16_f32 v190, v116, v117
  v_cvt_pk_bf16_f32 v191, v118, v119
  v_pk_mul_f32 v[88:89], v[88:89], s[92:93] op_sel_hi:[1,0]
  v_pk_mul_f32 v[90:91], v[90:91], s[92:93] op_sel_hi:[1,0]
  v_pk_mul_f32 v[92:93], v[92:93], s[92:93] op_sel_hi:[1,0]
  v_pk_mul_f32 v[94:95], v[94:95], s[92:93] op_sel_hi:[1,0]
  v_pk_mul_f32 v[96:97], v[96:97], s[92:93] op_sel_hi:[1,0]
  v_pk_mul_f32 v[98:99], v[98:99], s[92:93] op_sel_hi:[1,0]
  v_pk_mul_f32 v[100:101], v[100:101], s[92:93] op_sel_hi:[1,0]
  v_pk_mul_f32 v[102:103], v[102:103], s[92:93] op_sel_hi:[1,0]
  v_cvt_pk_bf16_f32 v200, v88, v89
  v_cvt_pk_bf16_f32 v201, v90, v91
  v_cvt_pk_bf16_f32 v202, v92, v93
  v_cvt_pk_bf16_f32 v203, v94, v95
  v_cvt_pk_bf16_f32 v204, v96, v97
  v_cvt_pk_bf16_f32 v205, v98, v99
  v_cvt_pk_bf16_f32 v206, v100, v101
  v_cvt_pk_bf16_f32 v207, v102, v103
  s_mov_b32 exec_lo, 0
  v_mov_b32 v190, 0x3f803f80
  v_mov_b32 v191, 0x00003f80
  v_mov_b32 v206, 0
  v_mov_b32 v207, 0
  s_mov_b32 exec_lo, -1
  buffer_store_dwordx4 v[184:187], v2, s[32:35], s0 offen sc1
  buffer_store_dwordx4 v[188:191], v2, s[32:35], s0 offen offset:1024 sc1
  v_mfma_f32_32x32x16_bf16 v[104:119], v[184:187], v[200:203], v[40:55]
  v_mfma_f32_32x32x16_bf16 v[104:119], v[188:191], v[204:207], v[104:119]
  v_cvt_pk_bf16_f32 v208, v152, v153
  v_cvt_pk_bf16_f32 v209, v154, v155
  v_cvt_pk_bf16_f32 v210, v156, v157
  v_cvt_pk_bf16_f32 v211, v158, v159
  v_cvt_pk_bf16_f32 v212, v160, v161
  v_cvt_pk_bf16_f32 v213, v162, v163
  v_cvt_pk_bf16_f32 v214, v164, v165
  v_cvt_pk_bf16_f32 v215, v166, v167
  v_pk_mul_f32 v[136:137], v[136:137], s[92:93] op_sel_hi:[1,0]
  v_pk_mul_f32 v[138:139], v[138:139], s[92:93] op_sel_hi:[1,0]
  v_pk_mul_f32 v[140:141], v[140:141], s[92:93] op_sel_hi:[1,0]
  v_pk_mul_f32 v[142:143], v[142:143], s[92:93] op_sel_hi:[1,0]
  v_pk_mul_f32 v[144:145], v[144:145], s[92:93] op_sel_hi:[1,0]
  v_pk_mul_f32 v[146:147], v[146:147], s[92:93] op_sel_hi:[1,0]
  v_pk_mul_f32 v[148:149], v[148:149], s[92:93] op_sel_hi:[1,0]
  v_pk_mul_f32 v[150:151], v[150:151], s[92:93] op_sel_hi:[1,0]
  v_cvt_pk_bf16_f32 v224, v136, v137
  v_cvt_pk_bf16_f32 v225, v138, v139
  v_cvt_pk_bf16_f32 v226, v140, v141
  v_cvt_pk_bf16_f32 v227, v142, v143
  v_cvt_pk_bf16_f32 v228, v144, v145
  v_cvt_pk_bf16_f32 v229, v146, v147
  v_cvt_pk_bf16_f32 v230, v148, v149
  v_cvt_pk_bf16_f32 v231, v150, v151
  s_mov_b32 exec_lo, 0
  v_mov_b32 v214, 0x3f803f80
  v_mov_b32 v215, 0x00003f80
  v_mov_b32 v230, 0
  v_mov_b32 v231, 0
  s_mov_b32 exec_lo, -1
  buffer_store_dwordx4 v[208:211], v2, s[32:35], s22 offen sc1
  buffer_store_dwordx4 v[212:215], v2, s[32:35], s22 offen offset:1024 sc1
  v_mfma_f32_32x32x16_bf16 v[152:167], v[208:211], v[224:227], v[40:55]
  v_mfma_f32_32x32x16_bf16 v[152:167], v[212:215], v[228:231], v[152:167]
  v_cvt_pk_bf16_f32 v192, v120, v121
  v_cvt_pk_bf16_f32 v193, v122, v123
  v_cvt_pk_bf16_f32 v194, v124, v125
  v_cvt_pk_bf16_f32 v195, v126, v127
  v_cvt_pk_bf16_f32 v196, v128, v129
  v_cvt_pk_bf16_f32 v197, v130, v131
  v_cvt_pk_bf16_f32 v198, v132, v133
  v_cvt_pk_bf16_f32 v199, v134, v135
  v_cndmask_b32_e64 v192, v192, v10, s[64:65]
  v_cndmask_b32_e64 v193, v193, v10, s[64:65]
  v_cndmask_b32_e64 v194, v194, v10, s[64:65]
  v_cndmask_b32_e64 v195, v195, v10, s[64:65]
  v_cndmask_b32_e64 v196, v196, v10, s[64:65]
  v_cndmask_b32_e64 v197, v197, v10, s[64:65]
  v_cndmask_b32_e64 v198, v198, v10, s[64:65]
  v_cndmask_b32_e64 v199, v199, v10, s[64:65]
  buffer_store_dwordx4 v[192:195], v2, s[32:35], s1 offen sc1
  buffer_store_dwordx4 v[196:199], v2, s[32:35], s1 offen offset:1024 sc1
  v_cvt_pk_bf16_f32 v216, v168, v169
  v_cvt_pk_bf16_f32 v217, v170, v171
  v_cvt_pk_bf16_f32 v218, v172, v173
  v_cvt_pk_bf16_f32 v219, v174, v175
  v_cvt_pk_bf16_f32 v220, v176, v177
  v_cvt_pk_bf16_f32 v221, v178, v179
  v_cvt_pk_bf16_f32 v222, v180, v181
  v_cvt_pk_bf16_f32 v223, v182, v183
  v_cndmask_b32_e64 v216, v216, v10, s[64:65]
  v_cndmask_b32_e64 v217, v217, v10, s[64:65]
  v_cndmask_b32_e64 v218, v218, v10, s[64:65]
  v_cndmask_b32_e64 v219, v219, v10, s[64:65]
  v_cndmask_b32_e64 v220, v220, v10, s[64:65]
  v_cndmask_b32_e64 v221, v221, v10, s[64:65]
  v_cndmask_b32_e64 v222, v222, v10, s[64:65]
  v_cndmask_b32_e64 v223, v223, v10, s[64:65]
  buffer_store_dwordx4 v[216:219], v2, s[32:35], s23 offen sc1
  buffer_store_dwordx4 v[220:223], v2, s[32:35], s23 offen offset:1024 sc1
  v_max3_f32 v6, v104, v105, v106
  v_max3_f32 v3, v107, v108, v109
  v_max3_f32 v6, v6, v110, v111
  v_max3_f32 v3, v3, v112, v113
  v_max3_f32 v6, v6, v114, v115
  v_max3_f32 v3, v3, v116, v117
  v_max3_f32 v6, v6, v118, v119
  v_max_f32 v6, v6, v3
  v_mov_b32 v3, v6
  s_nop 1
  v_permlane32_swap_b32 v6, v3
  v_max_f32 v6, v6, v3
  v_add_f32 v6, 0x42800000, v6
  v_and_b32 v3, 0xffff0000, v6
  v_sub_f32 v4, v6, v3
  v_and_b32 v5, 0xffff0000, v4
  v_sub_f32 v4, v4, v5
  v_lshrrev_b32 v3, 16, v3
  v_or_b32 v3, v3, v5
  v_xor_b32 v3, 0x80008000, v3
  v_lshrrev_b32 v4, 16, v4
  v_xor_b32 v4, 0x8000, v4
  s_mov_b32 exec_lo, 0
  v_mov_b32 v206, v3
  v_mov_b32 v207, v4
  s_mov_b32 exec_lo, -1
  buffer_store_dwordx4 v[200:203], v2, s[32:35], s3 offen sc1
  buffer_store_dwordx4 v[204:207], v2, s[32:35], s3 offen offset:1024 sc1
  v_max3_f32 v6, v152, v153, v154
  v_max3_f32 v3, v155, v156, v157
  v_max3_f32 v6, v6, v158, v159
  v_max3_f32 v3, v3, v160, v161
  v_max3_f32 v6, v6, v162, v163
  v_max3_f32 v3, v3, v164, v165
  v_max3_f32 v6, v6, v166, v167
  v_max_f32 v6, v6, v3
  v_mov_b32 v3, v6
  s_nop 1
  v_permlane32_swap_b32 v6, v3
  v_max_f32 v6, v6, v3
  v_add_f32 v6, 0x42800000, v6
  v_and_b32 v3, 0xffff0000, v6
  v_sub_f32 v4, v6, v3
  v_and_b32 v5, 0xffff0000, v4
  v_sub_f32 v4, v4, v5
  v_lshrrev_b32 v3, 16, v3
  v_or_b32 v3, v3, v5
  v_xor_b32 v3, 0x80008000, v3
  v_lshrrev_b32 v4, 16, v4
  v_xor_b32 v4, 0x8000, v4
  s_mov_b32 exec_lo, 0
  v_mov_b32 v230, v3
  v_mov_b32 v231, v4
  s_mov_b32 exec_lo, -1
  buffer_store_dwordx4 v[224:227], v2, s[32:35], s101 offen sc1
  buffer_store_dwordx4 v[228:231], v2, s[32:35], s101 offen offset:1024 sc1
  v_mov_b32 v3, 0
  v_mov_b32 v4, s66
  s_waitcnt vmcnt(0)
  s_mov_b64 exec, 1
  buffer_store_dword v4, v3, s[32:35], s85 offen sc1
  s_mov_b64 exec, -1
L_stored_6:
  s_barrier
  s_add_u32 s24, s20, s86
  s_addc_u32 s25, s21, 0
  s_and_b32 s25, s25, 0xffff
  s_mov_b32 s4, 0
  s_mov_b64 exec, 0xff
  buffer_load_dwordx4 v[180:183], v8, s[32:35], 0 offen sc1
  s_mov_b64 exec, -1
  s_waitcnt vmcnt(0)
  s_mov_b64 exec, 0xff
  v_xor_b32 v188, s66, v180
  v_xor_b32 v181, s66, v181
  v_xor_b32 v182, s66, v182
  v_xor_b32 v183, s66, v183
  v_or3_b32 v188, v188, v181, v182
  v_or_b32 v188, v188, v183
  v_cmp_ne_u32 vcc, 0, v188
  s_mov_b32 s73, 0
  s_cbranch_vccz L_pbd_9
  buffer_load_dwordx4 v[180:183], v8, s[32:35], 0 offen sc1
L_pb_8:
  buffer_load_dwordx4 v[184:187], v8, s[32:35], 0 offen sc1
  s_waitcnt vmcnt(1)
  v_xor_b32 v188, s66, v180
  v_xor_b32 v181, s66, v181
  v_xor_b32 v182, s66, v182
  v_xor_b32 v183, s66, v183
  v_or3_b32 v188, v188, v181, v182
  v_or_b32 v188, v188, v183
  v_cmp_ne_u32 vcc, 0, v188
  s_add_u32 s73, s73, 1
  s_cbranch_vccz L_pbd_9
  buffer_load_dwordx4 v[180:183], v8, s[32:35], 0 offen sc1
  s_waitcnt vmcnt(1)
  v_xor_b32 v188, s66, v184
  v_xor_b32 v185, s66, v185
  v_xor_b32 v186, s66, v186
  v_xor_b32 v187, s66, v187
  v_or3_b32 v188, v188, v185, v186
  v_or_b32 v188, v188, v187
  v_cmp_ne_u32 vcc, 0, v188
  s_cmp_gt_u32 s73, 262144
  s_cbranch_scc1 L_pbd_9
  s_cbranch_vccnz L_pb_8
L_pbd_9:
  s_mov_b64 exec, -1
  s_mov_b32 s26, 0x10000
  s_mov_b32 s27, 0x20000
  s_add_u32 s52, s48, 1
  s_and_b32 s52, s52, 3
  s_lshl_b32 s53, s80, 2
  s_add_u32 s52, s52, s53
  s_lshl_b32 s53, s67, 6
  s_add_u32 s52, s52, s53
  s_lshl_b32 s98, s52, 11
  s_add_u32 s98, s98, 12582912
  buffer_load_dwordx4 v[76:79], v2, s[32:35], s98 offen offset:0 sc1
  buffer_load_dwordx4 v[80:83], v2, s[32:35], s98 offen offset:1024 sc1
  s_add_u32 s52, s87, 0
  s_and_b32 s52, s52, 15
  s_lshl_b32 s52, s52, 12
  s_add_u32 s98, s52, s86
  buffer_load_dwordx4 a[0:3], v2, s[32:35], s98 offen offset:0 sc1
  buffer_load_dwordx4 a[4:7], v2, s[32:35], s98 offen offset:1024 sc1
  s_add_u32 s52, s48, 2
  s_and_b32 s52, s52, 3
  s_lshl_b32 s53, s80, 2
  s_add_u32 s52, s52, s53
  s_lshl_b32 s53, s67, 6
  s_add_u32 s52, s52, s53
  s_lshl_b32 s98, s52, 11
  s_add_u32 s98, s98, 12582912
  buffer_load_dwordx4 v[84:87], v2, s[32:35], s98 offen offset:0 sc1
  buffer_load_dwordx4 v[88:91], v2, s[32:35], s98 offen offset:1024 sc1
  s_add_u32 s52, s87, 0
  s_and_b32 s52, s52, 15
  s_lshl_b32 s52, s52, 12
  s_add_u32 s98, s52, s86
  buffer_load_dwordx4 a[8:11], v2, s[32:35], s98 offen offset:2048 sc1
  buffer_load_dwordx4 a[12:15], v2, s[32:35], s98 offen offset:3072 sc1
  s_add_u32 s52, s48, 3
  s_and_b32 s52, s52, 3
  s_lshl_b32 s53, s80, 2
  s_add_u32 s52, s52, s53
  s_lshl_b32 s53, s67, 6
  s_add_u32 s52, s52, s53
  s_lshl_b32 s98, s52, 11
  s_add_u32 s98, s98, 12582912
  buffer_load_dwordx4 v[92:95], v2, s[32:35], s98 offen offset:0 sc1
  buffer_load_dwordx4 v[96:99], v2, s[32:35], s98 offen offset:1024 sc1
  v_add_u32 v18, 6144, v7
  s_lshl_b32 s69, s67, 18
  s_add_u32 s69, s69, 4194304
  s_waitcnt vmcnt(6)
  v_mfma_f32_32x32x16_bf16 v[100:115], a[0:3], v[76:79], 0
  s_add_u32 s52, s48, 0
  s_and_b32 s52, s52, 3
  s_lshl_b32 s53, s80, 2
  s_add_u32 s52, s52, s53
  s_lshl_b32 s53, s67, 6
  s_add_u32 s52, s52, s53
  s_lshl_b32 s98, s52, 11
  s_add_u32 s98, s98, 12582912
  buffer_load_dwordx4 v[68:71], v2, s[32:35], s98 offen offset:0 sc1
  buffer_load_dwordx4 v[72:75], v2, s[32:35], s98 offen offset:1024 sc1
  v_mfma_f32_32x32x16_bf16 v[100:115], a[4:7], v[80:83], v[100:115]
  s_waitcnt vmcnt(6)
  s_mov_b32 s98, 4096
  s_nop 11
  v_mfma_f32_32x32x16_bf16 v[116:131], a[0:3], v[84:87], 0
  buffer_load_dwordx4 a[16:19], v2, s[24:27], s98 offen offset:0 sc1
  buffer_load_dwordx4 a[20:23], v2, s[24:27], s98 offen offset:1024 sc1
  v_exp_f32 v100, v100
  v_exp_f32 v101, v101
  v_exp_f32 v102, v102
  v_exp_f32 v103, v103
  v_cvt_pk_bf16_f32 v132, v100, v101
  v_cvt_pk_bf16_f32 v133, v102, v103
  v_mfma_f32_32x32x16_bf16 v[116:131], a[4:7], v[88:91], v[116:131]
  v_exp_f32 v104, v104
  v_exp_f32 v105, v105
  v_exp_f32 v106, v106
  v_exp_f32 v107, v107
  v_cvt_pk_bf16_f32 v134, v104, v105
  v_cvt_pk_bf16_f32 v135, v106, v107
  v_exp_f32 v108, v108
  v_exp_f32 v109, v109
  v_exp_f32 v110, v110
  v_exp_f32 v111, v111
  v_cvt_pk_bf16_f32 v136, v108, v109
  v_cvt_pk_bf16_f32 v137, v110, v111
  s_waitcnt vmcnt(4)
  v_exp_f32 v112, v112
  v_exp_f32 v113, v113
  v_exp_f32 v114, v114
  v_exp_f32 v115, v115
  v_cvt_pk_bf16_f32 v138, v112, v113
  v_cvt_pk_bf16_f32 v139, v114, v115
  v_mfma_f32_32x32x16_bf16 v[100:115], a[0:3], v[92:95], 0
  buffer_load_dwordx4 a[24:27], v2, s[24:27], s98 offen offset:2048 sc1
  buffer_load_dwordx4 a[28:31], v2, s[24:27], s98 offen offset:3072 sc1
  v_exp_f32 v116, v116
  v_exp_f32 v117, v117
  v_exp_f32 v118, v118
  v_exp_f32 v119, v119
  v_cvt_pk_bf16_f32 v140, v116, v117
  v_cvt_pk_bf16_f32 v141, v118, v119
  v_mfma_f32_32x32x16_bf16 v[100:115], a[4:7], v[96:99], v[100:115]
  s_mov_b32 s98, 8192
  v_exp_f32 v120, v120
  v_exp_f32 v121, v121
  v_exp_f32 v122, v122
  v_exp_f32 v123, v123
  v_cvt_pk_bf16_f32 v142, v120, v121
  v_cvt_pk_bf16_f32 v143, v122, v123
  v_mfma_f32_32x32x16_bf16 v[52:67], a[8:11], v[132:135], 0
  buffer_load_dwordx4 a[32:35], v2, s[24:27], s98 offen offset:0 sc1
  buffer_load_dwordx4 a[36:39], v2, s[24:27], s98 offen offset:1024 sc1
  v_exp_f32 v124, v124
  v_exp_f32 v125, v125
  v_exp_f32 v126, v126
  v_exp_f32 v127, v127
  v_cvt_pk_bf16_f32 v144, v124, v125
  v_cvt_pk_bf16_f32 v145, v126, v127
  v_mfma_f32_32x32x16_bf16 v[52:67], a[12:15], v[136:139], v[52:67]
  s_waitcnt vmcnt(6)
  s_lshl_b32 s53, s67, 6
  s_add_u32 s53, s53, s89
  s_lshl_b32 s99, s53, 11
  s_add_u32 s99, s99, 14680064
  v_exp_f32 v128, v128
  v_exp_f32 v129, v129
  v_exp_f32 v130, v130
  v_exp_f32 v131, v131
  v_cvt_pk_bf16_f32 v146, v128, v129
  v_cvt_pk_bf16_f32 v147, v130, v131
  v_mfma_f32_32x32x16_bf16 v[116:131], a[0:3], v[68:71], 0
  buffer_load_dwordx4 v[20:23], v2, s[32:35], s99 offen sc1
  buffer_load_dwordx4 v[24:27], v2, s[32:35], s99 offen offset:1024 sc1
  v_exp_f32 v100, v100
  v_exp_f32 v101, v101
  v_exp_f32 v102, v102
  v_exp_f32 v103, v103
  v_cvt_pk_bf16_f32 v132, v100, v101
  v_cvt_pk_bf16_f32 v133, v102, v103
  v_mfma_f32_32x32x16_bf16 v[116:131], a[4:7], v[72:75], v[116:131]
  s_mul_i32 s52, s48, 3
  s_lshl_b32 s53, s80, 2
  s_add_u32 s52, s52, s53
  s_add_i32 s53, s52, -8
  s_lshl_b32 s99, s53, 12
  s_add_u32 s99, s99, s69
  s_cmp_lt_i32 s53, 0
  s_cselect_b32 s99, 18874368, s99
  s_mul_i32 s52, s48, 12288
  s_add_u32 m0, s52, 114688
  v_exp_f32 v104, v104
  v_exp_f32 v105, v105
  v_exp_f32 v106, v106
  v_exp_f32 v107, v107
  v_cvt_pk_bf16_f32 v134, v104, v105
  v_cvt_pk_bf16_f32 v135, v106, v107
  v_mfma_f32_32x32x16_bf16 v[148:163], a[8:11], v[140:143], 0
  buffer_load_dwordx4 v2, s[32:35], s99 offen offset:0 sc1 lds
  buffer_load_dwordx4 v2, s[32:35], s99 offen offset:1024 sc1 lds
  v_exp_f32 v108, v108
  v_exp_f32 v109, v109
  v_exp_f32 v110, v110
  v_exp_f32 v111, v111
  v_cvt_pk_bf16_f32 v136, v108, v109
  v_cvt_pk_bf16_f32 v137, v110, v111
  v_mfma_f32_32x32x16_bf16 v[148:163], a[12:15], v[144:147], v[148:163]
  s_waitcnt vmcnt(8)
  v_exp_f32 v112, v112
  v_exp_f32 v113, v113
  v_exp_f32 v114, v114
  v_exp_f32 v115, v115
  v_cvt_pk_bf16_f32 v138, v112, v113
  v_cvt_pk_bf16_f32 v139, v114, v115
  v_mfma_f32_32x32x16_bf16 v[100:115], a[16:19], v[76:79], 0
  buffer_load_dwordx4 a[40:43], v2, s[24:27], s98 offen offset:2048 sc1
  buffer_load_dwordx4 a[44:47], v2, s[24:27], s98 offen offset:3072 sc1
  v_exp_f32 v116, v116
  v_exp_f32 v117, v117
  v_exp_f32 v118, v118
  v_exp_f32 v119, v119
  v_cvt_pk_bf16_f32 v140, v116, v117
  v_cvt_pk_bf16_f32 v141, v118, v119
  v_mfma_f32_32x32x16_bf16 v[100:115], a[20:23], v[80:83], v[100:115]
  s_mul_i32 s52, s48, 12288
  s_add_u32 m0, s52, 114688
  v_exp_f32 v120, v120
  v_exp_f32 v121, v121
  v_exp_f32 v122, v122
  v_exp_f32 v123, v123
  v_cvt_pk_bf16_f32 v142, v120, v121
  v_cvt_pk_bf16_f32 v143, v122, v123
  v_mfma_f32_32x32x16_bf16 v[164:179], a[8:11], v[132:135], 0
  buffer_load_dwordx4 v2, s[32:35], s99 offen offset:2048 sc1 lds
  buffer_load_dwordx4 v2, s[32:35], s99 offen offset:3072 sc1 lds
  v_exp_f32 v124, v124
  v_exp_f32 v125, v125
  v_exp_f32 v126, v126
  v_exp_f32 v127, v127
  v_cvt_pk_bf16_f32 v144, v124, v125
  v_cvt_pk_bf16_f32 v145, v126, v127
  v_mfma_f32_32x32x16_bf16 v[164:179], a[12:15], v[136:139], v[164:179]
  s_mul_i32 s52, s48, 3
  s_lshl_b32 s53, s80, 2
  s_add_u32 s52, s52, s53
  s_add_i32 s53, s52, -7
  s_lshl_b32 s99, s53, 12
  s_add_u32 s99, s99, s69
  s_cmp_lt_i32 s53, 0
  s_cselect_b32 s99, 18874368, s99
  s_mul_i32 s52, s48, 12288
  s_add_u32 m0, s52, 118784
  v_exp_f32 v128, v128
  v_exp_f32 v129, v129
  v_exp_f32 v130, v130
  v_exp_f32 v131, v131
  v_cvt_pk_bf16_f32 v146, v128, v129
  v_cvt_pk_bf16_f32 v147, v130, v131
  v_mfma_f32_32x32x16_bf16 v[116:131], a[16:19], v[84:87], 0
  buffer_load_dwordx4 v2, s[32:35], s99 offen offset:0 sc1 lds
  buffer_load_dwordx4 v2, s[32:35], s99 offen offset:1024 sc1 lds
  v_exp_f32 v100, v100
  v_exp_f32 v101, v101
  v_exp_f32 v102, v102
  v_exp_f32 v103, v103
  v_cvt_pk_bf16_f32 v132, v100, v101
  v_cvt_pk_bf16_f32 v133, v102, v103
  v_mfma_f32_32x32x16_bf16 v[116:131], a[20:23], v[88:91], v[116:131]
  v_exp_f32 v104, v104
  v_exp_f32 v105, v105
  v_exp_f32 v106, v106
  v_exp_f32 v107, v107
  v_cvt_pk_bf16_f32 v134, v104, v105
  v_cvt_pk_bf16_f32 v135, v106, v107
  v_mfma_f32_32x32x16_bf16 v[36:51], a[8:11], v[140:143], 0
  v_exp_f32 v108, v108
  v_exp_f32 v109, v109
  v_exp_f32 v110, v110
  v_exp_f32 v111, v111
  v_cvt_pk_bf16_f32 v136, v108, v109
  v_cvt_pk_bf16_f32 v137, v110, v111
  v_mfma_f32_32x32x16_bf16 v[36:51], a[12:15], v[144:147], v[36:51]
  s_mov_b32 s98, 12288
  v_exp_f32 v112, v112
  v_exp_f32 v113, v113
  v_exp_f32 v114, v114
  v_exp_f32 v115, v115
  v_cvt_pk_bf16_f32 v138, v112, v113
  v_cvt_pk_bf16_f32 v139, v114, v115
  v_mfma_f32_32x32x16_bf16 v[100:115], a[16:19], v[92:95], 0
  buffer_load_dwordx4 a[48:51], v2, s[24:27], s98 offen offset:0 sc1
  buffer_load_dwordx4 a[52:55], v2, s[24:27], s98 offen offset:1024 sc1
  v_exp_f32 v116, v116
  v_exp_f32 v117, v117
  v_exp_f32 v118, v118
  v_exp_f32 v119, v119
  v_cvt_pk_bf16_f32 v140, v116, v117
  v_cvt_pk_bf16_f32 v141, v118, v119
  v_mfma_f32_32x32x16_bf16 v[100:115], a[20:23], v[96:99], v[100:115]
  s_waitcnt vmcnt(14)
  s_mul_i32 s52, s48, 12288
  s_add_u32 m0, s52, 118784
  v_exp_f32 v120, v120
  v_exp_f32 v121, v121
  v_exp_f32 v122, v122
  v_exp_f32 v123, v123
  v_cvt_pk_bf16_f32 v142, v120, v121
  v_cvt_pk_bf16_f32 v143, v122, v123
  v_mfma_f32_32x32x16_bf16 v[52:67], a[24:27], v[132:135], v[52:67]
  buffer_load_dwordx4 v2, s[32:35], s99 offen offset:2048 sc1 lds
  buffer_load_dwordx4 v2, s[32:35], s99 offen offset:3072 sc1 lds
  v_exp_f32 v124, v124
  v_exp_f32 v125, v125
  v_exp_f32 v126, v126
  v_exp_f32 v127, v127
  v_cvt_pk_bf16_f32 v144, v124, v125
  v_cvt_pk_bf16_f32 v145, v126, v127
  v_mfma_f32_32x32x16_bf16 v[52:67], a[28:31], v[136:139], v[52:67]
  s_mul_i32 s52, s48, 3
  s_lshl_b32 s53, s80, 2
  s_add_u32 s52, s52, s53
  s_add_i32 s53, s52, -6
  s_lshl_b32 s99, s53, 12
  s_add_u32 s99, s99, s69
  s_cmp_lt_i32 s53, 0
  s_cselect_b32 s99, 18874368, s99
  s_mul_i32 s52, s48, 12288
  s_add_u32 m0, s52, 122880
  v_exp_f32 v128, v128
  v_exp_f32 v129, v129
  v_exp_f32 v130, v130
  v_exp_f32 v131, v131
  v_cvt_pk_bf16_f32 v146, v128, v129
  v_cvt_pk_bf16_f32 v147, v130, v131
  v_mfma_f32_32x32x16_bf16 v[116:131], a[16:19], v[68:71], 0
  buffer_load_dwordx4 v2, s[32:35], s99 offen offset:0 sc1 lds
  buffer_load_dwordx4 v2, s[32:35], s99 offen offset:1024 sc1 lds
  v_exp_f32 v100, v100
  v_exp_f32 v101, v101
  v_exp_f32 v102, v102
  v_exp_f32 v103, v103
  v_cvt_pk_bf16_f32 v132, v100, v101
  v_cvt_pk_bf16_f32 v133, v102, v103
  v_mfma_f32_32x32x16_bf16 v[116:131], a[20:23], v[72:75], v[116:131]
  v_exp_f32 v104, v104
  v_exp_f32 v105, v105
  v_exp_f32 v106, v106
  v_exp_f32 v107, v107
  v_cvt_pk_bf16_f32 v134, v104, v105
  v_cvt_pk_bf16_f32 v135, v106, v107
  v_mfma_f32_32x32x16_bf16 v[148:163], a[24:27], v[140:143], v[148:163]
  v_exp_f32 v108, v108
  v_exp_f32 v109, v109
  v_exp_f32 v110, v110
  v_exp_f32 v111, v111
  v_cvt_pk_bf16_f32 v136, v108, v109
  v_cvt_pk_bf16_f32 v137, v110, v111
  v_mfma_f32_32x32x16_bf16 v[148:163], a[28:31], v[144:147], v[148:163]
  s_waitcnt vmcnt(16)
  v_exp_f32 v112, v112
  v_exp_f32 v113, v113
  v_exp_f32 v114, v114
  v_exp_f32 v115, v115
  v_cvt_pk_bf16_f32 v138, v112, v113
  v_cvt_pk_bf16_f32 v139, v114, v115
  v_mfma_f32_32x32x16_bf16 v[100:115], a[32:35], v[76:79], 0
  buffer_load_dwordx4 a[56:59], v2, s[24:27], s98 offen offset:2048 sc1
  buffer_load_dwordx4 a[60:63], v2, s[24:27], s98 offen offset:3072 sc1
  v_exp_f32 v116, v116
  v_exp_f32 v117, v117
  v_exp_f32 v118, v118
  v_exp_f32 v119, v119
  v_cvt_pk_bf16_f32 v140, v116, v117
  v_cvt_pk_bf16_f32 v141, v118, v119
  v_mfma_f32_32x32x16_bf16 v[100:115], a[36:39], v[80:83], v[100:115]
  s_mul_i32 s52, s48, 12288
  s_add_u32 m0, s52, 122880
  v_exp_f32 v120, v120
  v_exp_f32 v121, v121
  v_exp_f32 v122, v122
  v_exp_f32 v123, v123
  v_cvt_pk_bf16_f32 v142, v120, v121
  v_cvt_pk_bf16_f32 v143, v122, v123
  v_mfma_f32_32x32x16_bf16 v[164:179], a[24:27], v[132:135], v[164:179]
  buffer_load_dwordx4 v2, s[32:35], s99 offen offset:2048 sc1 lds
  buffer_load_dwordx4 v2, s[32:35], s99 offen offset:3072 sc1 lds
  v_exp_f32 v124, v124
  v_exp_f32 v125, v125
  v_exp_f32 v126, v126
  v_exp_f32 v127, v127
  v_cvt_pk_bf16_f32 v144, v124, v125
  v_cvt_pk_bf16_f32 v145, v126, v127
  v_mfma_f32_32x32x16_bf16 v[164:179], a[28:31], v[136:139], v[164:179]
  v_exp_f32 v128, v128
  v_exp_f32 v129, v129
  v_exp_f32 v130, v130
  v_exp_f32 v131, v131
  v_cvt_pk_bf16_f32 v146, v128, v129
  v_cvt_pk_bf16_f32 v147, v130, v131
  v_mfma_f32_32x32x16_bf16 v[116:131], a[32:35], v[84:87], 0
  v_exp_f32 v100, v100
  v_exp_f32 v101, v101
  v_exp_f32 v102, v102
  v_exp_f32 v103, v103
  v_cvt_pk_bf16_f32 v132, v100, v101
  v_cvt_pk_bf16_f32 v133, v102, v103
  v_mfma_f32_32x32x16_bf16 v[116:131], a[36:39], v[88:91], v[116:131]
  v_exp_f32 v104, v104
  v_exp_f32 v105, v105
  v_exp_f32 v106, v106
  v_exp_f32 v107, v107
  v_cvt_pk_bf16_f32 v134, v104, v105
  v_cvt_pk_bf16_f32 v135, v106, v107
  v_mfma_f32_32x32x16_bf16 v[36:51], a[24:27], v[140:143], v[36:51]
  v_exp_f32 v108, v108
  v_exp_f32 v109, v109
  v_exp_f32 v110, v110
  v_exp_f32 v111, v111
  v_cvt_pk_bf16_f32 v136, v108, v109
  v_cvt_pk_bf16_f32 v137, v110, v111
  v_mfma_f32_32x32x16_bf16 v[36:51], a[28:31], v[144:147], v[36:51]
  v_exp_f32 v112, v112
  v_exp_f32 v113, v113
  v_exp_f32 v114, v114
  v_exp_f32 v115, v115
  v_cvt_pk_bf16_f32 v138, v112, v113
  v_cvt_pk_bf16_f32 v139, v114, v115
  v_mfma_f32_32x32x16_bf16 v[100:115], a[32:35], v[92:95], 0
  v_exp_f32 v116, v116
  v_exp_f32 v117, v117
  v_exp_f32 v118, v118
  v_exp_f32 v119, v119
  v_cvt_pk_bf16_f32 v140, v116, v117
  v_cvt_pk_bf16_f32 v141, v118, v119
  v_mfma_f32_32x32x16_bf16 v[100:115], a[36:39], v[96:99], v[100:115]
  s_waitcnt vmcnt(14)
  v_exp_f32 v120, v120
  v_exp_f32 v121, v121
  v_exp_f32 v122, v122
  v_exp_f32 v123, v123
  v_cvt_pk_bf16_f32 v142, v120, v121
  v_cvt_pk_bf16_f32 v143, v122, v123
  v_mfma_f32_32x32x16_bf16 v[52:67], a[40:43], v[132:135], v[52:67]
  v_exp_f32 v124, v124
  v_exp_f32 v125, v125
  v_exp_f32 v126, v126
  v_exp_f32 v127, v127
  v_cvt_pk_bf16_f32 v144, v124, v125
  v_cvt_pk_bf16_f32 v145, v126, v127
  v_mfma_f32_32x32x16_bf16 v[52:67], a[44:47], v[136:139], v[52:67]
  v_exp_f32 v128, v128
  v_exp_f32 v129, v129
  v_exp_f32 v130, v130
  v_exp_f32 v131, v131
  v_cvt_pk_bf16_f32 v146, v128, v129
  v_cvt_pk_bf16_f32 v147, v130, v131
  v_mfma_f32_32x32x16_bf16 v[116:131], a[32:35], v[68:71], 0
  v_exp_f32 v100, v100
  v_exp_f32 v101, v101
  v_exp_f32 v102, v102
  v_exp_f32 v103, v103
  v_cvt_pk_bf16_f32 v132, v100, v101
  v_cvt_pk_bf16_f32 v133, v102, v103
  v_mfma_f32_32x32x16_bf16 v[116:131], a[36:39], v[72:75], v[116:131]
  v_exp_f32 v104, v104
  v_exp_f32 v105, v105
  v_exp_f32 v106, v106
  v_exp_f32 v107, v107
  v_cvt_pk_bf16_f32 v134, v104, v105
  v_cvt_pk_bf16_f32 v135, v106, v107
  v_mfma_f32_32x32x16_bf16 v[148:163], a[40:43], v[140:143], v[148:163]
  v_exp_f32 v108, v108
  v_exp_f32 v109, v109
  v_exp_f32 v110, v110
  v_exp_f32 v111, v111
  v_cvt_pk_bf16_f32 v136, v108, v109
  v_cvt_pk_bf16_f32 v137, v110, v111
  v_mfma_f32_32x32x16_bf16 v[148:163], a[44:47], v[144:147], v[148:163]
  s_waitcnt vmcnt(8)
  s_mov_b32 s98, 16384
  v_exp_f32 v112, v112
  v_exp_f32 v113, v113
  v_exp_f32 v114, v114
  v_exp_f32 v115, v115
  v_cvt_pk_bf16_f32 v138, v112, v113
  v_cvt_pk_bf16_f32 v139, v114, v115
  v_mfma_f32_32x32x16_bf16 v[100:115], a[48:51], v[76:79], 0
  buffer_load_dwordx4 a[64:67], v2, s[24:27], s98 offen offset:0 sc1
  buffer_load_dwordx4 a[68:71], v2, s[24:27], s98 offen offset:1024 sc1
  v_exp_f32 v116, v116
  v_exp_f32 v117, v117
  v_exp_f32 v118, v118
  v_exp_f32 v119, v119
  v_cvt_pk_bf16_f32 v140, v116, v117
  v_cvt_pk_bf16_f32 v141, v118, v119
  v_mfma_f32_32x32x16_bf16 v[100:115], a[52:55], v[80:83], v[100:115]
  v_exp_f32 v120, v120
  v_exp_f32 v121, v121
  v_exp_f32 v122, v122
  v_exp_f32 v123, v123
  v_cvt_pk_bf16_f32 v142, v120, v121
  v_cvt_pk_bf16_f32 v143, v122, v123
  v_mfma_f32_32x32x16_bf16 v[164:179], a[40:43], v[132:135], v[164:179]
  v_exp_f32 v124, v124
  v_exp_f32 v125, v125
  v_exp_f32 v126, v126
  v_exp_f32 v127, v127
  v_cvt_pk_bf16_f32 v144, v124, v125
  v_cvt_pk_bf16_f32 v145, v126, v127
  v_mfma_f32_32x32x16_bf16 v[164:179], a[44:47], v[136:139], v[164:179]
  v_exp_f32 v128, v128
  v_exp_f32 v129, v129
  v_exp_f32 v130, v130
  v_exp_f32 v131, v131
  v_cvt_pk_bf16_f32 v146, v128, v129
  v_cvt_pk_bf16_f32 v147, v130, v131
  v_mfma_f32_32x32x16_bf16 v[116:131], a[48:51], v[84:87], 0
  buffer_load_dwordx4 a[72:75], v2, s[24:27], s98 offen offset:2048 sc1
  buffer_load_dwordx4 a[76:79], v2, s[24:27], s98 offen offset:3072 sc1
  v_exp_f32 v100, v100
  v_exp_f32 v101, v101
  v_exp_f32 v102, v102
  v_exp_f32 v103, v103
  v_cvt_pk_bf16_f32 v132, v100, v101
  v_cvt_pk_bf16_f32 v133, v102, v103
  v_mfma_f32_32x32x16_bf16 v[116:131], a[52:55], v[88:91], v[116:131]
  v_exp_f32 v104, v104
  v_exp_f32 v105, v105
  v_exp_f32 v106, v106
  v_exp_f32 v107, v107
  v_cvt_pk_bf16_f32 v134, v104, v105
  v_cvt_pk_bf16_f32 v135, v106, v107
  v_mfma_f32_32x32x16_bf16 v[36:51], a[40:43], v[140:143], v[36:51]
  v_exp_f32 v108, v108
  v_exp_f32 v109, v109
  v_exp_f32 v110, v110
  v_exp_f32 v111, v111
  v_cvt_pk_bf16_f32 v136, v108, v109
  v_cvt_pk_bf16_f32 v137, v110, v111
  v_mfma_f32_32x32x16_bf16 v[36:51], a[44:47], v[144:147], v[36:51]
  v_exp_f32 v112, v112
  v_exp_f32 v113, v113
  v_exp_f32 v114, v114
  v_exp_f32 v115, v115
  v_cvt_pk_bf16_f32 v138, v112, v113
  v_cvt_pk_bf16_f32 v139, v114, v115
  v_mfma_f32_32x32x16_bf16 v[100:115], a[48:51], v[92:95], 0
  v_exp_f32 v116, v116
  v_exp_f32 v117, v117
  v_exp_f32 v118, v118
  v_exp_f32 v119, v119
  v_cvt_pk_bf16_f32 v140, v116, v117
  v_cvt_pk_bf16_f32 v141, v118, v119
  v_mfma_f32_32x32x16_bf16 v[100:115], a[52:55], v[96:99], v[100:115]
  s_waitcnt vmcnt(6)
  v_exp_f32 v120, v120
  v_exp_f32 v121, v121
  v_exp_f32 v122, v122
  v_exp_f32 v123, v123
  v_cvt_pk_bf16_f32 v142, v120, v121
  v_cvt_pk_bf16_f32 v143, v122, v123
  s_waitcnt vmcnt(4)
  s_barrier
  s_lshl_b32 s52, s48, 12
  s_add_u32 s52, s52, 114688
  v_add_u32 v191, s52, v2
  ds_read_b128 a[0:3], v191 offset:0
  ds_read_b128 a[4:7], v191 offset:1024
  v_mov_b32 v4, 0xf149f2ca
  v_sub_f32 v192, v4, v240
  v_sub_f32 v193, v4, v241
  v_sub_f32 v194, v4, v242
  v_sub_f32 v195, v4, v243
  v_sub_f32 v196, v4, v244
  v_sub_f32 v197, v4, v245
  v_sub_f32 v198, v4, v246
  v_sub_f32 v199, v4, v247
  v_sub_f32 v200, v4, v248
  v_sub_f32 v201, v4, v249
  v_sub_f32 v202, v4, v250
  v_sub_f32 v203, v4, v251
  v_sub_f32 v204, v4, v252
  v_sub_f32 v205, v4, v253
  v_sub_f32 v206, v4, v254
  v_sub_f32 v207, v4, v255
  v_mfma_f32_32x32x16_bf16 v[52:67], a[56:59], v[132:135], v[52:67]
  v_exp_f32 v124, v124
  v_exp_f32 v125, v125
  v_exp_f32 v126, v126
  v_exp_f32 v127, v127
  v_cvt_pk_bf16_f32 v144, v124, v125
  v_cvt_pk_bf16_f32 v145, v126, v127
  v_mfma_f32_32x32x16_bf16 v[52:67], a[60:63], v[136:139], v[52:67]
  s_lshl_b32 s52, s74, 7
  s_mul_i32 s53, s48, 100352
  s_add_u32 s90, s52, s53
  s_mul_i32 s94, s48, 14336
  s_add_u32 s94, s94, 57344
  s_add_u32 m0, s94, 0
  v_exp_f32 v128, v128
  v_exp_f32 v129, v129
  v_exp_f32 v130, v130
  v_exp_f32 v131, v131
  v_cvt_pk_bf16_f32 v146, v128, v129
  v_cvt_pk_bf16_f32 v147, v130, v131
  v_mfma_f32_32x32x16_bf16 v[116:131], a[48:51], v[68:71], 0
  buffer_load_dwordx4 v7, s[44:47], s90 offen lds
  buffer_load_dwordx4 v18, s[44:47], s90 offen offset:1024 lds
  v_exp_f32 v100, v100
  v_exp_f32 v101, v101
  v_exp_f32 v102, v102
  v_exp_f32 v103, v103
  v_cvt_pk_bf16_f32 v132, v100, v101
  v_cvt_pk_bf16_f32 v133, v102, v103
  v_mfma_f32_32x32x16_bf16 v[116:131], a[52:55], v[72:75], v[116:131]
  v_exp_f32 v104, v104
  v_exp_f32 v105, v105
  v_exp_f32 v106, v106
  v_exp_f32 v107, v107
  v_cvt_pk_bf16_f32 v134, v104, v105
  v_cvt_pk_bf16_f32 v135, v106, v107
  v_mfma_f32_32x32x16_bf16 v[148:163], a[56:59], v[140:143], v[148:163]
  v_exp_f32 v108, v108
  v_exp_f32 v109, v109
  v_exp_f32 v110, v110
  v_exp_f32 v111, v111
  v_cvt_pk_bf16_f32 v136, v108, v109
  v_cvt_pk_bf16_f32 v137, v110, v111
  v_mfma_f32_32x32x16_bf16 v[148:163], a[60:63], v[144:147], v[148:163]
  s_waitcnt lgkmcnt(0)
  s_mov_b32 s98, 20480
  ds_read_b128 a[16:19], v191 offset:4096
  ds_read_b128 a[20:23], v191 offset:5120
  v_exp_f32 v112, v112
  v_exp_f32 v113, v113
  v_exp_f32 v114, v114
  v_exp_f32 v115, v115
  v_cvt_pk_bf16_f32 v138, v112, v113
  v_cvt_pk_bf16_f32 v139, v114, v115
  v_mfma_f32_32x32x16_bf16 v[100:115], a[0:3], v[20:23], v[192:207]
  buffer_load_dwordx4 a[80:83], v2, s[24:27], s98 offen offset:0 sc1
  buffer_load_dwordx4 a[84:87], v2, s[24:27], s98 offen offset:1024 sc1
  v_exp_f32 v116, v116
  v_exp_f32 v117, v117
  v_exp_f32 v118, v118
  v_exp_f32 v119, v119
  v_cvt_pk_bf16_f32 v140, v116, v117
  v_cvt_pk_bf16_f32 v141, v118, v119
  v_mfma_f32_32x32x16_bf16 v[100:115], a[4:7], v[24:27], v[100:115]
  v_exp_f32 v120, v120
  v_exp_f32 v121, v121
  v_exp_f32 v122, v122
  v_exp_f32 v123, v123
  v_cvt_pk_bf16_f32 v142, v120, v121
  v_cvt_pk_bf16_f32 v143, v122, v123
  v_mfma_f32_32x32x16_bf16 v[164:179], a[56:59], v[132:135], v[164:179]
  v_exp_f32 v124, v124
  v_exp_f32 v125, v125
  v_exp_f32 v126, v126
  v_exp_f32 v127, v127
  v_cvt_pk_bf16_f32 v144, v124, v125
  v_cvt_pk_bf16_f32 v145, v126, v127
  v_mfma_f32_32x32x16_bf16 v[164:179], a[60:63], v[136:139], v[164:179]
  s_waitcnt lgkmcnt(0)
  ds_read_b128 a[32:35], v191 offset:8192
  ds_read_b128 a[36:39], v191 offset:9216
  v_exp_f32 v128, v128
  v_exp_f32 v129, v129
  v_exp_f32 v130, v130
  v_exp_f32 v131, v131
  v_cvt_pk_bf16_f32 v146, v128, v129
  v_cvt_pk_bf16_f32 v147, v130, v131
  v_mfma_f32_32x32x16_bf16 v[116:131], a[16:19], v[20:23], 0
  buffer_load_dwordx4 a[88:91], v2, s[24:27], s98 offen offset:2048 sc1
  buffer_load_dwordx4 a[92:95], v2, s[24:27], s98 offen offset:3072 sc1
  v_exp_f32 v100, v100
  v_exp_f32 v101, v101
  v_exp_f32 v102, v102
  v_exp_f32 v103, v103
  v_cvt_pk_bf16_f32 v132, v100, v101
  v_cvt_pk_bf16_f32 v133, v102, v103
  v_mfma_f32_32x32x16_bf16 v[116:131], a[20:23], v[24:27], v[116:131]
  ds_read_b128 a[8:11], v191 offset:2048
  ds_read_b128 a[12:15], v191 offset:3072
  v_exp_f32 v104, v104
  v_exp_f32 v105, v105
  v_exp_f32 v106, v106
  v_exp_f32 v107, v107
  v_cvt_pk_bf16_f32 v134, v104, v105
  v_cvt_pk_bf16_f32 v135, v106, v107
  v_mfma_f32_32x32x16_bf16 v[36:51], a[56:59], v[140:143], v[36:51]
  v_exp_f32 v108, v108
  v_exp_f32 v109, v109
  v_exp_f32 v110, v110
  v_exp_f32 v111, v111
  v_cvt_pk_bf16_f32 v136, v108, v109
  v_cvt_pk_bf16_f32 v137, v110, v111
  v_mfma_f32_32x32x16_bf16 v[36:51], a[60:63], v[144:147], v[36:51]
  s_waitcnt lgkmcnt(2)
  s_add_u32 s90, s90, 14336
  s_add_u32 m0, s94, 2048
  ds_read_b128 a[0:3], v191 offset:12288
  ds_read_b128 a[4:7], v191 offset:13312
  v_exp_f32 v112, v112
  v_exp_f32 v113, v113
  v_exp_f32 v114, v114
  v_exp_f32 v115, v115
  v_cvt_pk_bf16_f32 v138, v112, v113
  v_cvt_pk_bf16_f32 v139, v114, v115
  v_mfma_f32_32x32x16_bf16 v[100:115], a[32:35], v[20:23], 0
  buffer_load_dwordx4 v7, s[44:47], s90 offen lds
  buffer_load_dwordx4 v18, s[44:47], s90 offen offset:1024 lds
  v_exp_f32 v116, v116
  v_exp_f32 v117, v117
  v_exp_f32 v118, v118
  v_exp_f32 v119, v119
  v_cvt_pk_bf16_f32 v140, v116, v117
  v_cvt_pk_bf16_f32 v141, v118, v119
  v_mfma_f32_32x32x16_bf16 v[100:115], a[36:39], v[24:27], v[100:115]
  s_waitcnt lgkmcnt(2)
  ds_read_b128 a[24:27], v191 offset:6144
  ds_read_b128 a[28:31], v191 offset:7168
  v_exp_f32 v120, v120
  v_exp_f32 v121, v121
  v_exp_f32 v122, v122
  v_exp_f32 v123, v123
  v_cvt_pk_bf16_f32 v142, v120, v121
  v_cvt_pk_bf16_f32 v143, v122, v123
  v_mfma_f32_32x32x16_bf16 v[224:239], a[8:11], v[132:135], 0
  v_exp_f32 v124, v124
  v_exp_f32 v125, v125
  v_exp_f32 v126, v126
  v_exp_f32 v127, v127
  v_cvt_pk_bf16_f32 v144, v124, v125
  v_cvt_pk_bf16_f32 v145, v126, v127
  v_mfma_f32_32x32x16_bf16 v[224:239], a[12:15], v[136:139], v[224:239]
  s_waitcnt lgkmcnt(2)
  s_add_u32 s90, s90, 14336
  s_add_u32 m0, s94, 4096
  ds_read_b128 a[16:19], v191 offset:16384
  ds_read_b128 a[20:23], v191 offset:17408
  v_exp_f32 v128, v128
  v_exp_f32 v129, v129
  v_exp_f32 v130, v130
  v_exp_f32 v131, v131
  v_cvt_pk_bf16_f32 v146, v128, v129
  v_cvt_pk_bf16_f32 v147, v130, v131
  v_mfma_f32_32x32x16_bf16 v[116:131], a[0:3], v[20:23], 0
  buffer_load_dwordx4 v7, s[44:47], s90 offen lds
  buffer_load_dwordx4 v18, s[44:47], s90 offen offset:1024 lds
  v_exp_f32 v100, v100
  v_exp_f32 v101, v101
  v_exp_f32 v102, v102
  v_exp_f32 v103, v103
  v_cvt_pk_bf16_f32 v132, v100, v101
  v_cvt_pk_bf16_f32 v133, v102, v103
  v_mfma_f32_32x32x16_bf16 v[116:131], a[4:7], v[24:27], v[116:131]
  s_waitcnt lgkmcnt(2)
  ds_read_b128 a[40:43], v191 offset:10240
  ds_read_b128 a[44:47], v191 offset:11264
  v_exp_f32 v104, v104
  v_exp_f32 v105, v105
  v_exp_f32 v106, v106
  v_exp_f32 v107, v107
  v_cvt_pk_bf16_f32 v134, v104, v105
  v_cvt_pk_bf16_f32 v135, v106, v107
  v_mfma_f32_32x32x16_bf16 v[224:239], a[24:27], v[140:143], v[224:239]
  v_exp_f32 v108, v108
  v_exp_f32 v109, v109
  v_exp_f32 v110, v110
  v_exp_f32 v111, v111
  v_cvt_pk_bf16_f32 v136, v108, v109
  v_cvt_pk_bf16_f32 v137, v110, v111
  v_mfma_f32_32x32x16_bf16 v[224:239], a[28:31], v[144:147], v[224:239]
  s_waitcnt lgkmcnt(2)
  s_mov_b32 s98, 24576
  ds_read_b128 a[32:35], v191 offset:20480
  ds_read_b128 a[36:39], v191 offset:21504
  v_exp_f32 v112, v112
  v_exp_f32 v113, v113
  v_exp_f32 v114, v114
  v_exp_f32 v115, v115
  v_cvt_pk_bf16_f32 v138, v112, v113
  v_cvt_pk_bf16_f32 v139, v114, v115
  v_mfma_f32_32x32x16_bf16 v[100:115], a[16:19], v[20:23], 0
  buffer_load_dwordx4 a[96:99], v2, s[24:27], s98 offen offset:0 sc1
  buffer_load_dwordx4 a[100:103], v2, s[24:27], s98 offen offset:1024 sc1
  v_exp_f32 v116, v116
  v_exp_f32 v117, v117
  v_exp_f32 v118, v118
  v_exp_f32 v119, v119
  v_cvt_pk_bf16_f32 v140, v116, v117
  v_cvt_pk_bf16_f32 v141, v118, v119
  v_mfma_f32_32x32x16_bf16 v[100:115], a[20:23], v[24:27], v[100:115]
  s_waitcnt lgkmcnt(2)
  ds_read_b128 a[8:11], v191 offset:14336
  ds_read_b128 a[12:15], v191 offset:15360
  v_exp_f32 v120, v120
  v_exp_f32 v121, v121
  v_exp_f32 v122, v122
  v_exp_f32 v123, v123
  v_cvt_pk_bf16_f32 v142, v120, v121
  v_cvt_pk_bf16_f32 v143, v122, v123
  v_mfma_f32_32x32x16_bf16 v[224:239], a[40:43], v[132:135], v[224:239]
  v_exp_f32 v124, v124
  v_exp_f32 v125, v125
  v_exp_f32 v126, v126
  v_exp_f32 v127, v127
  v_cvt_pk_bf16_f32 v144, v124, v125
  v_cvt_pk_bf16_f32 v145, v126, v127
  v_mfma_f32_32x32x16_bf16 v[224:239], a[44:47], v[136:139], v[224:239]
  s_waitcnt lgkmcnt(2)
  ds_read_b128 a[0:3], v191 offset:24576
  ds_read_b128 a[4:7], v191 offset:25600
  v_exp_f32 v128, v128
  v_exp_f32 v129, v129
  v_exp_f32 v130, v130
  v_exp_f32 v131, v131
  v_cvt_pk_bf16_f32 v146, v128, v129
  v_cvt_pk_bf16_f32 v147, v130, v131
  v_mfma_f32_32x32x16_bf16 v[116:131], a[32:35], v[20:23], 0
  buffer_load_dwordx4 a[104:107], v2, s[24:27], s98 offen offset:2048 sc1
  buffer_load_dwordx4 a[108:111], v2, s[24:27], s98 offen offset:3072 sc1
  v_exp_f32 v100, v100
  v_exp_f32 v101, v101
  v_exp_f32 v102, v102
  v_exp_f32 v103, v103
  v_cvt_pk_bf16_f32 v132, v100, v101
  v_cvt_pk_bf16_f32 v133, v102, v103
  v_mfma_f32_32x32x16_bf16 v[116:131], a[36:39], v[24:27], v[116:131]
  s_waitcnt lgkmcnt(2)
  ds_read_b128 a[24:27], v191 offset:18432
  ds_read_b128 a[28:31], v191 offset:19456
  v_exp_f32 v104, v104
  v_exp_f32 v105, v105
  v_exp_f32 v106, v106
  v_exp_f32 v107, v107
  v_cvt_pk_bf16_f32 v134, v104, v105
  v_cvt_pk_bf16_f32 v135, v106, v107
  v_mfma_f32_32x32x16_bf16 v[224:239], a[8:11], v[140:143], v[224:239]
  v_exp_f32 v108, v108
  v_exp_f32 v109, v109
  v_exp_f32 v110, v110
  v_exp_f32 v111, v111
  v_cvt_pk_bf16_f32 v136, v108, v109
  v_cvt_pk_bf16_f32 v137, v110, v111
  v_mfma_f32_32x32x16_bf16 v[224:239], a[12:15], v[144:147], v[224:239]
  s_waitcnt lgkmcnt(2)
  s_add_u32 s90, s90, 14336
  s_add_u32 m0, s94, 6144
  ds_read_b128 a[16:19], v191 offset:28672
  ds_read_b128 a[20:23], v191 offset:29696
  v_exp_f32 v112, v112
  v_exp_f32 v113, v113
  v_exp_f32 v114, v114
  v_exp_f32 v115, v115
  v_cvt_pk_bf16_f32 v138, v112, v113
  v_cvt_pk_bf16_f32 v139, v114, v115
  v_mfma_f32_32x32x16_bf16 v[100:115], a[0:3], v[20:23], 0
  buffer_load_dwordx4 v7, s[44:47], s90 offen lds
  buffer_load_dwordx4 v18, s[44:47], s90 offen offset:1024 lds
  v_exp_f32 v116, v116
  v_exp_f32 v117, v117
  v_exp_f32 v118, v118
  v_exp_f32 v119, v119
  v_cvt_pk_bf16_f32 v140, v116, v117
  v_cvt_pk_bf16_f32 v141, v118, v119
  v_mfma_f32_32x32x16_bf16 v[100:115], a[4:7], v[24:27], v[100:115]
  s_waitcnt lgkmcnt(2)
  ds_read_b128 a[40:43], v191 offset:22528
  ds_read_b128 a[44:47], v191 offset:23552
  v_exp_f32 v120, v120
  v_exp_f32 v121, v121
  v_exp_f32 v122, v122
  v_exp_f32 v123, v123
  v_cvt_pk_bf16_f32 v142, v120, v121
  v_cvt_pk_bf16_f32 v143, v122, v123
  v_mfma_f32_32x32x16_bf16 v[224:239], a[24:27], v[132:135], v[224:239]
  v_exp_f32 v124, v124
  v_exp_f32 v125, v125
  v_exp_f32 v126, v126
  v_exp_f32 v127, v127
  v_cvt_pk_bf16_f32 v144, v124, v125
  v_cvt_pk_bf16_f32 v145, v126, v127
  v_mfma_f32_32x32x16_bf16 v[224:239], a[28:31], v[136:139], v[224:239]
  s_waitcnt lgkmcnt(2)
  s_add_u32 s90, s90, 14336
  s_add_u32 m0, s94, 8192
  ds_read_b128 a[32:35], v191 offset:32768
  ds_read_b128 a[36:39], v191 offset:33792
  v_exp_f32 v128, v128
  v_exp_f32 v129, v129
  v_exp_f32 v130, v130
  v_exp_f32 v131, v131
  v_cvt_pk_bf16_f32 v146, v128, v129
  v_cvt_pk_bf16_f32 v147, v130, v131
  v_mfma_f32_32x32x16_bf16 v[116:131], a[16:19], v[20:23], 0
  buffer_load_dwordx4 v7, s[44:47], s90 offen lds
  buffer_load_dwordx4 v18, s[44:47], s90 offen offset:1024 lds
  v_exp_f32 v100, v100
  v_exp_f32 v101, v101
  v_exp_f32 v102, v102
  v_exp_f32 v103, v103
  v_cvt_pk_bf16_f32 v132, v100, v101
  v_cvt_pk_bf16_f32 v133, v102, v103
  v_mfma_f32_32x32x16_bf16 v[116:131], a[20:23], v[24:27], v[116:131]
  s_waitcnt lgkmcnt(2)
  ds_read_b128 a[8:11], v191 offset:26624
  ds_read_b128 a[12:15], v191 offset:27648
  v_exp_f32 v104, v104
  v_exp_f32 v105, v105
  v_exp_f32 v106, v106
  v_exp_f32 v107, v107
  v_cvt_pk_bf16_f32 v134, v104, v105
  v_cvt_pk_bf16_f32 v135, v106, v107
  v_mfma_f32_32x32x16_bf16 v[224:239], a[40:43], v[140:143], v[224:239]
  v_exp_f32 v108, v108
  v_exp_f32 v109, v109
  v_exp_f32 v110, v110
  v_exp_f32 v111, v111
  v_cvt_pk_bf16_f32 v136, v108, v109
  v_cvt_pk_bf16_f32 v137, v110, v111
  v_mfma_f32_32x32x16_bf16 v[224:239], a[44:47], v[144:147], v[224:239]
  s_waitcnt lgkmcnt(2)
  s_mov_b32 s98, 28672
  v_exp_f32 v112, v112
  v_exp_f32 v113, v113
  v_exp_f32 v114, v114
  v_exp_f32 v115, v115
  v_cvt_pk_bf16_f32 v138, v112, v113
  v_cvt_pk_bf16_f32 v139, v114, v115
  v_mfma_f32_32x32x16_bf16 v[100:115], a[32:35], v[20:23], v[240:255]
  buffer_load_dwordx4 a[112:115], v2, s[24:27], s98 offen offset:0 sc1
  buffer_load_dwordx4 a[116:119], v2, s[24:27], s98 offen offset:1024 sc1
  v_exp_f32 v116, v116
  v_exp_f32 v117, v117
  v_exp_f32 v118, v118
  v_exp_f32 v119, v119
  v_cvt_pk_bf16_f32 v140, v116, v117
  v_cvt_pk_bf16_f32 v141, v118, v119
  v_mfma_f32_32x32x16_bf16 v[100:115], a[36:39], v[24:27], v[100:115]
  s_waitcnt lgkmcnt(0)
  ds_read_b128 a[24:27], v191 offset:30720
  ds_read_b128 a[28:31], v191 offset:31744
  v_exp_f32 v120, v120
  v_exp_f32 v121, v121
  v_exp_f32 v122, v122
  v_exp_f32 v123, v123
  v_cvt_pk_bf16_f32 v142, v120, v121
  v_cvt_pk_bf16_f32 v143, v122, v123
  v_mfma_f32_32x32x16_bf16 v[224:239], a[8:11], v[132:135], v[224:239]
  v_exp_f32 v124, v124
  v_exp_f32 v125, v125
  v_exp_f32 v126, v126
  v_exp_f32 v127, v127
  v_cvt_pk_bf16_f32 v144, v124, v125
  v_cvt_pk_bf16_f32 v145, v126, v127
  v_mfma_f32_32x32x16_bf16 v[224:239], a[12:15], v[136:139], v[224:239]
  s_waitcnt vmcnt(22)
  v_exp_f32 v128, v128
  v_exp_f32 v129, v129
  v_exp_f32 v130, v130
  v_exp_f32 v131, v131
  v_cvt_pk_bf16_f32 v146, v128, v129
  v_cvt_pk_bf16_f32 v147, v130, v131
  v_mfma_f32_32x32x16_bf16 v[116:131], a[64:67], v[76:79], 0
  buffer_load_dwordx4 a[120:123], v2, s[24:27], s98 offen offset:2048 sc1
  buffer_load_dwordx4 a[124:127], v2, s[24:27], s98 offen offset:3072 sc1
  v_exp_f32 v100, v100
  v_exp_f32 v101, v101
  v_exp_f32 v102, v102
  v_exp_f32 v103, v103
  v_cvt_pk_bf16_f32 v132, v100, v101
  v_cvt_pk_bf16_f32 v133, v102, v103
  v_mfma_f32_32x32x16_bf16 v[116:131], a[68:71], v[80:83], v[116:131]
  s_waitcnt lgkmcnt(0)
  ds_read_b128 a[40:43], v191 offset:34816
  ds_read_b128 a[44:47], v191 offset:35840
  v_exp_f32 v104, v104
  v_exp_f32 v105, v105
  v_exp_f32 v106, v106
  v_exp_f32 v107, v107
  v_cvt_pk_bf16_f32 v134, v104, v105
  v_cvt_pk_bf16_f32 v135, v106, v107
  v_mfma_f32_32x32x16_bf16 v[224:239], a[24:27], v[140:143], v[224:239]
  v_exp_f32 v108, v108
  v_exp_f32 v109, v109
  v_exp_f32 v110, v110
  v_exp_f32 v111, v111
  v_cvt_pk_bf16_f32 v136, v108, v109
  v_cvt_pk_bf16_f32 v137, v110, v111
  v_mfma_f32_32x32x16_bf16 v[224:239], a[28:31], v[144:147], v[224:239]
  s_add_u32 s90, s90, 14336
  s_add_u32 m0, s94, 10240
  v_exp_f32 v112, v112
  v_exp_f32 v113, v113
  v_exp_f32 v114, v114
  v_exp_f32 v115, v115
  v_cvt_pk_bf16_f32 v138, v112, v113
  v_cvt_pk_bf16_f32 v139, v114, v115
  v_mfma_f32_32x32x16_bf16 v[100:115], a[64:67], v[84:87], 0
  buffer_load_dwordx4 v7, s[44:47], s90 offen lds
  buffer_load_dwordx4 v18, s[44:47], s90 offen offset:1024 lds
  v_exp_f32 v116, v116
  v_exp_f32 v117, v117
  v_exp_f32 v118, v118
  v_exp_f32 v119, v119
  v_cvt_pk_bf16_f32 v140, v116, v117
  v_cvt_pk_bf16_f32 v141, v118, v119
  v_mfma_f32_32x32x16_bf16 v[100:115], a[68:71], v[88:91], v[100:115]
  s_waitcnt lgkmcnt(0)
  v_exp_f32 v120, v120
  v_exp_f32 v121, v121
  v_exp_f32 v122, v122
  v_exp_f32 v123, v123
  v_cvt_pk_bf16_f32 v142, v120, v121
  v_cvt_pk_bf16_f32 v143, v122, v123
  v_mfma_f32_32x32x16_bf16 v[224:239], a[40:43], v[132:135], v[224:239]
  v_exp_f32 v124, v124
  v_exp_f32 v125, v125
  v_exp_f32 v126, v126
  v_exp_f32 v127, v127
  v_cvt_pk_bf16_f32 v144, v124, v125
  v_cvt_pk_bf16_f32 v145, v126, v127
  v_mfma_f32_32x32x16_bf16 v[224:239], a[44:47], v[136:139], v[224:239]
  s_add_u32 s90, s90, 14336
  s_add_u32 m0, s94, 12288
  v_exp_f32 v128, v128
  v_exp_f32 v129, v129
  v_exp_f32 v130, v130
  v_exp_f32 v131, v131
  v_cvt_pk_bf16_f32 v146, v128, v129
  v_cvt_pk_bf16_f32 v147, v130, v131
  v_mfma_f32_32x32x16_bf16 v[116:131], a[64:67], v[92:95], 0
  buffer_load_dwordx4 v7, s[44:47], s90 offen lds
  buffer_load_dwordx4 v18, s[44:47], s90 offen offset:1024 lds
  v_exp_f32 v100, v100
  v_exp_f32 v101, v101
  v_exp_f32 v102, v102
  v_exp_f32 v103, v103
  v_cvt_pk_bf16_f32 v132, v100, v101
  v_cvt_pk_bf16_f32 v133, v102, v103
  v_mfma_f32_32x32x16_bf16 v[116:131], a[68:71], v[96:99], v[116:131]
  s_waitcnt vmcnt(26)
  v_exp_f32 v104, v104
  v_exp_f32 v105, v105
  v_exp_f32 v106, v106
  v_exp_f32 v107, v107
  v_cvt_pk_bf16_f32 v134, v104, v105
  v_cvt_pk_bf16_f32 v135, v106, v107
  v_mfma_f32_32x32x16_bf16 v[52:67], a[72:75], v[140:143], v[52:67]
  v_exp_f32 v108, v108
  v_exp_f32 v109, v109
  v_exp_f32 v110, v110
  v_exp_f32 v111, v111
  v_cvt_pk_bf16_f32 v136, v108, v109
  v_cvt_pk_bf16_f32 v137, v110, v111
  v_mfma_f32_32x32x16_bf16 v[52:67], a[76:79], v[144:147], v[52:67]
  s_mov_b32 s98, 32768
  v_exp_f32 v112, v112
  v_exp_f32 v113, v113
  v_exp_f32 v114, v114
  v_exp_f32 v115, v115
  v_cvt_pk_bf16_f32 v138, v112, v113
  v_cvt_pk_bf16_f32 v139, v114, v115
  v_mfma_f32_32x32x16_bf16 v[100:115], a[64:67], v[68:71], 0
  buffer_load_dwordx4 a[128:131], v2, s[24:27], s98 offen offset:0 sc1
  buffer_load_dwordx4 a[132:135], v2, s[24:27], s98 offen offset:1024 sc1
  v_exp_f32 v116, v116
  v_exp_f32 v117, v117
  v_exp_f32 v118, v118
  v_exp_f32 v119, v119
  v_cvt_pk_bf16_f32 v140, v116, v117
  v_cvt_pk_bf16_f32 v141, v118, v119
  v_mfma_f32_32x32x16_bf16 v[100:115], a[68:71], v[72:75], v[100:115]
  v_exp_f32 v120, v120
  v_exp_f32 v121, v121
  v_exp_f32 v122, v122
  v_exp_f32 v123, v123
  v_cvt_pk_bf16_f32 v142, v120, v121
  v_cvt_pk_bf16_f32 v143, v122, v123
L_finA:
  v_mov_b32 v3, v236
  v_mov_b32 v4, v236
  v_pk_add_f32 v[28:29], v[224:225], v[226:227]
  v_pk_add_f32 v[30:31], v[228:229], v[230:231]
  v_permlane32_swap_b32 v3, v4
  v_pk_add_f32 v[28:29], v[28:29], v[232:233]
  v_pk_add_f32 v[30:31], v[30:31], v[234:235]
  v_pk_add_f32 v[28:29], v[28:29], v[236:237]
  v_pk_add_f32 v[30:31], v[30:31], v[238:239]
  s_mov_b32 s13, 0x207
  v_pk_add_f32 v[28:29], v[28:29], v[30:31]
  v_cmp_nlt_f32 vcc, 0xd800000, v4
  v_add_f32 v28, v28, v29
  s_mov_b32 s11, 0x5f800000
  v_cmp_ngt_f32_e64 s[76:77], s11, v4
  v_cmp_class_f32_e64 s[78:79], v28, s13
  v_rcp_f32 v4, v4
  s_or_b64 vcc, vcc, s[76:77]
  s_or_b64 vcc, vcc, s[78:79]
  s_bitcmp1_b32 s4, 0
  s_cselect_b64 vcc, 0, vcc
  s_cbranch_vccnz L_slowA
  v_mul_f32 v224, v224, v4
  v_mul_f32 v225, v225, v4
  v_mul_f32 v226, v226, v4
  v_mul_f32 v227, v227, v4
  v_mul_f32 v228, v228, v4
  v_mul_f32 v229, v229, v4
  v_mul_f32 v230, v230, v4
  v_mul_f32 v231, v231, v4
  v_mul_f32 v232, v232, v4
  v_mul_f32 v233, v233, v4
  v_mul_f32 v234, v234, v4
  v_mul_f32 v235, v235, v4
  v_mul_f32 v236, v236, v4
  v_mul_f32 v237, v237, v4
  v_mul_f32 v238, v238, v4
  v_mul_f32 v239, v239, v4
  v_cvt_pk_bf16_f32 v28, v224, v225
  v_cvt_pk_bf16_f32 v29, v226, v227
  v_cvt_pk_bf16_f32 v30, v228, v229
  v_cvt_pk_bf16_f32 v31, v230, v231
  v_cvt_pk_bf16_f32 v32, v232, v233
  v_cvt_pk_bf16_f32 v33, v234, v235
  v_cvt_pk_bf16_f32 v34, v236, v237
  v_cvt_pk_bf16_f32 v35, v238, v239
  s_mov_b32 exec_lo, 0
  v_mov_b32 v34, 0
  v_mov_b32 v35, 0
  s_mov_b32 exec_lo, -1
  s_lshl_b32 s52, s89, 4
  s_add_u32 s52, s52, s67
  s_lshl_b32 s72, s52, 11
  s_add_u32 s72, s72, 10485760
  buffer_store_dwordx4 v[28:31], v2, s[32:35], s72 offen sc1
  buffer_store_dwordx4 v[32:35], v2, s[32:35], s72 offen offset:1024 sc1
  s_lshl_b32 s84, s89, 2
  s_lshr_b32 s52, s67, 2
  s_add_u32 s84, s84, s52
  s_lshl_b32 s84, s84, 7
  s_and_b32 s52, s67, 3
  s_lshl_b32 s52, s52, 2
  s_add_u32 s84, s84, s52
  s_add_u32 s85, s84, 17039360
  s_add_u32 s84, s84, 17072128
  v_mfma_f32_32x32x16_bf16 v[148:163], a[72:75], v[132:135], v[148:163]
  v_exp_f32 v124, v124
  v_exp_f32 v125, v125
  v_exp_f32 v126, v126
  v_exp_f32 v127, v127
  v_cvt_pk_bf16_f32 v144, v124, v125
  v_cvt_pk_bf16_f32 v145, v126, v127
  v_mfma_f32_32x32x16_bf16 v[148:163], a[76:79], v[136:139], v[148:163]
  s_waitcnt vmcnt(26)
  v_exp_f32 v128, v128
  v_exp_f32 v129, v129
  v_exp_f32 v130, v130
  v_exp_f32 v131, v131
  v_cvt_pk_bf16_f32 v146, v128, v129
  v_cvt_pk_bf16_f32 v147, v130, v131
  v_mfma_f32_32x32x16_bf16 v[116:131], a[80:83], v[76:79], 0
  buffer_load_dwordx4 a[136:139], v2, s[24:27], s98 offen offset:2048 sc1
  buffer_load_dwordx4 a[140:143], v2, s[24:27], s98 offen offset:3072 sc1
  v_exp_f32 v100, v100
  v_exp_f32 v101, v101
  v_exp_f32 v102, v102
  v_exp_f32 v103, v103
  v_cvt_pk_bf16_f32 v132, v100, v101
  v_cvt_pk_bf16_f32 v133, v102, v103
  v_mfma_f32_32x32x16_bf16 v[116:131], a[84:87], v[80:83], v[116:131]
  v_exp_f32 v104, v104
  v_exp_f32 v105, v105
  v_exp_f32 v106, v106
  v_exp_f32 v107, v107
  v_cvt_pk_bf16_f32 v134, v104, v105
  v_cvt_pk_bf16_f32 v135, v106, v107
  v_mfma_f32_32x32x16_bf16 v[164:179], a[72:75], v[140:143], v[164:179]
  v_exp_f32 v108, v108
  v_exp_f32 v109, v109
  v_exp_f32 v110, v110
  v_exp_f32 v111, v111
  v_cvt_pk_bf16_f32 v136, v108, v109
  v_cvt_pk_bf16_f32 v137, v110, v111
  v_mfma_f32_32x32x16_bf16 v[164:179], a[76:79], v[144:147], v[164:179]
  s_lshl_b32 s52, s74, 7
  s_mul_i32 s53, s48, 100352
  s_add_u32 s90, s52, s53
  s_mul_i32 s94, s48, 14336
  s_add_u32 s94, s94, 0
  s_add_u32 m0, s94, 0
  v_exp_f32 v112, v112
  v_exp_f32 v113, v113
  v_exp_f32 v114, v114
  v_exp_f32 v115, v115
  v_cvt_pk_bf16_f32 v138, v112, v113
  v_cvt_pk_bf16_f32 v139, v114, v115
  v_mfma_f32_32x32x16_bf16 v[100:115], a[80:83], v[84:87], 0
  buffer_load_dwordx4 v7, s[40:43], s90 offen lds
  buffer_load_dwordx4 v18, s[40:43], s90 offen offset:1024 lds
  v_exp_f32 v116, v116
  v_exp_f32 v117, v117
  v_exp_f32 v118, v118
  v_exp_f32 v119, v119
  v_cvt_pk_bf16_f32 v140, v116, v117
  v_cvt_pk_bf16_f32 v141, v118, v119
  v_mfma_f32_32x32x16_bf16 v[100:115], a[84:87], v[88:91], v[100:115]
  v_exp_f32 v120, v120
  v_exp_f32 v121, v121
  v_exp_f32 v122, v122
  v_exp_f32 v123, v123
  v_cvt_pk_bf16_f32 v142, v120, v121
  v_cvt_pk_bf16_f32 v143, v122, v123
  v_mfma_f32_32x32x16_bf16 v[36:51], a[72:75], v[132:135], v[36:51]
  v_exp_f32 v124, v124
  v_exp_f32 v125, v125
  v_exp_f32 v126, v126
  v_exp_f32 v127, v127
  v_cvt_pk_bf16_f32 v144, v124, v125
  v_cvt_pk_bf16_f32 v145, v126, v127
  v_mfma_f32_32x32x16_bf16 v[36:51], a[76:79], v[136:139], v[36:51]
  s_add_u32 s90, s90, 14336
  s_add_u32 m0, s94, 2048
  v_exp_f32 v128, v128
  v_exp_f32 v129, v129
  v_exp_f32 v130, v130
  v_exp_f32 v131, v131
  v_cvt_pk_bf16_f32 v146, v128, v129
  v_cvt_pk_bf16_f32 v147, v130, v131
  v_mfma_f32_32x32x16_bf16 v[116:131], a[80:83], v[92:95], 0
  buffer_load_dwordx4 v7, s[40:43], s90 offen lds
  buffer_load_dwordx4 v18, s[40:43], s90 offen offset:1024 lds
  v_exp_f32 v100, v100
  v_exp_f32 v101, v101
  v_exp_f32 v102, v102
  v_exp_f32 v103, v103
  v_cvt_pk_bf16_f32 v132, v100, v101
  v_cvt_pk_bf16_f32 v133, v102, v103
  v_mfma_f32_32x32x16_bf16 v[116:131], a[84:87], v[96:99], v[116:131]
  s_waitcnt vmcnt(30)
  v_exp_f32 v104, v104
  v_exp_f32 v105, v105
  v_exp_f32 v106, v106
  v_exp_f32 v107, v107
  v_cvt_pk_bf16_f32 v134, v104, v105
  v_cvt_pk_bf16_f32 v135, v106, v107
  v_mfma_f32_32x32x16_bf16 v[52:67], a[88:91], v[140:143], v[52:67]
  v_exp_f32 v108, v108
  v_exp_f32 v109, v109
  v_exp_f32 v110, v110
  v_exp_f32 v111, v111
  v_cvt_pk_bf16_f32 v136, v108, v109
  v_cvt_pk_bf16_f32 v137, v110, v111
  v_mfma_f32_32x32x16_bf16 v[52:67], a[92:95], v[144:147], v[52:67]
  s_mov_b32 s98, 36864
  v_exp_f32 v112, v112
  v_exp_f32 v113, v113
  v_exp_f32 v114, v114
  v_exp_f32 v115, v115
  v_cvt_pk_bf16_f32 v138, v112, v113
  v_cvt_pk_bf16_f32 v139, v114, v115
  v_mfma_f32_32x32x16_bf16 v[100:115], a[80:83], v[68:71], 0
  buffer_load_dwordx4 a[144:147], v2, s[24:27], s98 offen offset:0 sc1
  buffer_load_dwordx4 a[148:151], v2, s[24:27], s98 offen offset:1024 sc1
  v_exp_f32 v116, v116
  v_exp_f32 v117, v117
  v_exp_f32 v118, v118
  v_exp_f32 v119, v119
  v_cvt_pk_bf16_f32 v140, v116, v117
  v_cvt_pk_bf16_f32 v141, v118, v119
  v_mfma_f32_32x32x16_bf16 v[100:115], a[84:87], v[72:75], v[100:115]
  v_exp_f32 v120, v120
  v_exp_f32 v121, v121
  v_exp_f32 v122, v122
  v_exp_f32 v123, v123
  v_cvt_pk_bf16_f32 v142, v120, v121
  v_cvt_pk_bf16_f32 v143, v122, v123
  v_mfma_f32_32x32x16_bf16 v[148:163], a[88:91], v[132:135], v[148:163]
  v_exp_f32 v124, v124
  v_exp_f32 v125, v125
  v_exp_f32 v126, v126
  v_exp_f32 v127, v127
  v_cvt_pk_bf16_f32 v144, v124, v125
  v_cvt_pk_bf16_f32 v145, v126, v127
  v_mfma_f32_32x32x16_bf16 v[148:163], a[92:95], v[136:139], v[148:163]
  s_waitcnt vmcnt(26)
  v_exp_f32 v128, v128
  v_exp_f32 v129, v129
  v_exp_f32 v130, v130
  v_exp_f32 v131, v131
  v_cvt_pk_bf16_f32 v146, v128, v129
  v_cvt_pk_bf16_f32 v147, v130, v131
  v_mfma_f32_32x32x16_bf16 v[116:131], a[96:99], v[76:79], 0
  buffer_load_dwordx4 a[152:155], v2, s[24:27], s98 offen offset:2048 sc1
  buffer_load_dwordx4 a[156:159], v2, s[24:27], s98 offen offset:3072 sc1
  v_exp_f32 v100, v100
  v_exp_f32 v101, v101
  v_exp_f32 v102, v102
  v_exp_f32 v103, v103
  v_cvt_pk_bf16_f32 v132, v100, v101
  v_cvt_pk_bf16_f32 v133, v102, v103
  v_mfma_f32_32x32x16_bf16 v[116:131], a[100:103], v[80:83], v[116:131]
  v_exp_f32 v104, v104
  v_exp_f32 v105, v105
  v_exp_f32 v106, v106
  v_exp_f32 v107, v107
  v_cvt_pk_bf16_f32 v134, v104, v105
  v_cvt_pk_bf16_f32 v135, v106, v107
  v_mfma_f32_32x32x16_bf16 v[164:179], a[88:91], v[140:143], v[164:179]
  v_exp_f32 v108, v108
  v_exp_f32 v109, v109
  v_exp_f32 v110, v110
  v_exp_f32 v111, v111
  v_cvt_pk_bf16_f32 v136, v108, v109
  v_cvt_pk_bf16_f32 v137, v110, v111
  v_mfma_f32_32x32x16_bf16 v[164:179], a[92:95], v[144:147], v[164:179]
  s_add_u32 s90, s90, 14336
  s_add_u32 m0, s94, 4096
  v_exp_f32 v112, v112
  v_exp_f32 v113, v113
  v_exp_f32 v114, v114
  v_exp_f32 v115, v115
  v_cvt_pk_bf16_f32 v138, v112, v113
  v_cvt_pk_bf16_f32 v139, v114, v115
  v_mfma_f32_32x32x16_bf16 v[100:115], a[96:99], v[84:87], 0
  buffer_load_dwordx4 v7, s[40:43], s90 offen lds
  buffer_load_dwordx4 v18, s[40:43], s90 offen offset:1024 lds
  v_exp_f32 v116, v116
  v_exp_f32 v117, v117
  v_exp_f32 v118, v118
  v_exp_f32 v119, v119
  v_cvt_pk_bf16_f32 v140, v116, v117
  v_cvt_pk_bf16_f32 v141, v118, v119
  v_mfma_f32_32x32x16_bf16 v[100:115], a[100:103], v[88:91], v[100:115]
  v_exp_f32 v120, v120
  v_exp_f32 v121, v121
  v_exp_f32 v122, v122
  v_exp_f32 v123, v123
  v_cvt_pk_bf16_f32 v142, v120, v121
  v_cvt_pk_bf16_f32 v143, v122, v123
  v_mfma_f32_32x32x16_bf16 v[36:51], a[88:91], v[132:135], v[36:51]
  v_exp_f32 v124, v124
  v_exp_f32 v125, v125
  v_exp_f32 v126, v126
  v_exp_f32 v127, v127
  v_cvt_pk_bf16_f32 v144, v124, v125
  v_cvt_pk_bf16_f32 v145, v126, v127
  v_mfma_f32_32x32x16_bf16 v[36:51], a[92:95], v[136:139], v[36:51]
  s_add_u32 s90, s90, 14336
  s_add_u32 m0, s94, 6144
  v_exp_f32 v128, v128
  v_exp_f32 v129, v129
  v_exp_f32 v130, v130
  v_exp_f32 v131, v131
  v_cvt_pk_bf16_f32 v146, v128, v129
  v_cvt_pk_bf16_f32 v147, v130, v131
  v_mfma_f32_32x32x16_bf16 v[116:131], a[96:99], v[92:95], 0
  buffer_load_dwordx4 v7, s[40:43], s90 offen lds
  buffer_load_dwordx4 v18, s[40:43], s90 offen offset:1024 lds
  v_exp_f32 v100, v100
  v_exp_f32 v101, v101
  v_exp_f32 v102, v102
  v_exp_f32 v103, v103
  v_cvt_pk_bf16_f32 v132, v100, v101
  v_cvt_pk_bf16_f32 v133, v102, v103
  v_mfma_f32_32x32x16_bf16 v[116:131], a[100:103], v[96:99], v[116:131]
  s_waitcnt vmcnt(30)
  v_exp_f32 v104, v104
  v_exp_f32 v105, v105
  v_exp_f32 v106, v106
  v_exp_f32 v107, v107
  v_cvt_pk_bf16_f32 v134, v104, v105
  v_cvt_pk_bf16_f32 v135, v106, v107
  v_mfma_f32_32x32x16_bf16 v[52:67], a[104:107], v[140:143], v[52:67]
  v_exp_f32 v108, v108
  v_exp_f32 v109, v109
  v_exp_f32 v110, v110
  v_exp_f32 v111, v111
  v_cvt_pk_bf16_f32 v136, v108, v109
  v_cvt_pk_bf16_f32 v137, v110, v111
  v_mfma_f32_32x32x16_bf16 v[52:67], a[108:111], v[144:147], v[52:67]
  s_mov_b32 s98, 40960
  v_exp_f32 v112, v112
  v_exp_f32 v113, v113
  v_exp_f32 v114, v114
  v_exp_f32 v115, v115
  v_cvt_pk_bf16_f32 v138, v112, v113
  v_cvt_pk_bf16_f32 v139, v114, v115
  v_mfma_f32_32x32x16_bf16 v[100:115], a[96:99], v[68:71], 0
  buffer_load_dwordx4 a[160:163], v2, s[24:27], s98 offen offset:0 sc1
  buffer_load_dwordx4 a[164:167], v2, s[24:27], s98 offen offset:1024 sc1
  v_exp_f32 v116, v116
  v_exp_f32 v117, v117
  v_exp_f32 v118, v118
  v_exp_f32 v119, v119
  v_cvt_pk_bf16_f32 v140, v116, v117
  v_cvt_pk_bf16_f32 v141, v118, v119
  v_mfma_f32_32x32x16_bf16 v[100:115], a[100:103], v[72:75], v[100:115]
  v_exp_f32 v120, v120
  v_exp_f32 v121, v121
  v_exp_f32 v122, v122
  v_exp_f32 v123, v123
  v_cvt_pk_bf16_f32 v142, v120, v121
  v_cvt_pk_bf16_f32 v143, v122, v123
  s_waitcnt vmcnt(16)
  v_mov_b32 v3, 0
  v_mov_b32 v4, s66
  s_mov_b64 exec, 1
  buffer_store_dword v4, v3, s[32:35], s84 offen sc1
  s_mov_b64 exec, -1
  s_lshl_b32 s52, s75, 3
  v_add_u32 v8, s52, v1
  v_lshlrev_b32 v8, 7, v8
  v_add_u32 v9, 17072128, v8
  v_add_u32 v8, 17039360, v8
  v_mfma_f32_32x32x16_bf16 v[148:163], a[104:107], v[132:135], v[148:163]
  v_exp_f32 v124, v124
  v_exp_f32 v125, v125
  v_exp_f32 v126, v126
  v_exp_f32 v127, v127
  v_cvt_pk_bf16_f32 v144, v124, v125
  v_cvt_pk_bf16_f32 v145, v126, v127
  v_mfma_f32_32x32x16_bf16 v[148:163], a[108:111], v[136:139], v[148:163]
  v_exp_f32 v128, v128
  v_exp_f32 v129, v129
  v_exp_f32 v130, v130
  v_exp_f32 v131, v131
  v_cvt_pk_bf16_f32 v146, v128, v129
  v_cvt_pk_bf16_f32 v147, v130, v131
  v_mfma_f32_32x32x16_bf16 v[116:131], a[112:115], v[76:79], 0
  buffer_load_dwordx4 a[168:171], v2, s[24:27], s98 offen offset:2048 sc1
  buffer_load_dwordx4 a[172:175], v2, s[24:27], s98 offen offset:3072 sc1
  v_exp_f32 v100, v100
  v_exp_f32 v101, v101
  v_exp_f32 v102, v102
  v_exp_f32 v103, v103
  v_cvt_pk_bf16_f32 v132, v100, v101
  v_cvt_pk_bf16_f32 v133, v102, v103
  v_mfma_f32_32x32x16_bf16 v[116:131], a[116:119], v[80:83], v[116:131]
  v_exp_f32 v104, v104
  v_exp_f32 v105, v105
  v_exp_f32 v106, v106
  v_exp_f32 v107, v107
  v_cvt_pk_bf16_f32 v134, v104, v105
  v_cvt_pk_bf16_f32 v135, v106, v107
  v_mfma_f32_32x32x16_bf16 v[164:179], a[104:107], v[140:143], v[164:179]
  v_exp_f32 v108, v108
  v_exp_f32 v109, v109
  v_exp_f32 v110, v110
  v_exp_f32 v111, v111
  v_cvt_pk_bf16_f32 v136, v108, v109
  v_cvt_pk_bf16_f32 v137, v110, v111
  v_mfma_f32_32x32x16_bf16 v[164:179], a[108:111], v[144:147], v[164:179]
  s_add_u32 s90, s90, 14336
  s_add_u32 m0, s94, 8192
  v_exp_f32 v112, v112
  v_exp_f32 v113, v113
  v_exp_f32 v114, v114
  v_exp_f32 v115, v115
  v_cvt_pk_bf16_f32 v138, v112, v113
  v_cvt_pk_bf16_f32 v139, v114, v115
  v_mfma_f32_32x32x16_bf16 v[100:115], a[112:115], v[84:87], 0
  buffer_load_dwordx4 v7, s[40:43], s90 offen lds
  buffer_load_dwordx4 v18, s[40:43], s90 offen offset:1024 lds
  v_exp_f32 v116, v116
  v_exp_f32 v117, v117
  v_exp_f32 v118, v118
  v_exp_f32 v119, v119
  v_cvt_pk_bf16_f32 v140, v116, v117
  v_cvt_pk_bf16_f32 v141, v118, v119
  v_mfma_f32_32x32x16_bf16 v[100:115], a[116:119], v[88:91], v[100:115]
  v_exp_f32 v120, v120
  v_exp_f32 v121, v121
  v_exp_f32 v122, v122
  v_exp_f32 v123, v123
  v_cvt_pk_bf16_f32 v142, v120, v121
  v_cvt_pk_bf16_f32 v143, v122, v123
  v_mfma_f32_32x32x16_bf16 v[36:51], a[104:107], v[132:135], v[36:51]
  v_exp_f32 v124, v124
  v_exp_f32 v125, v125
  v_exp_f32 v126, v126
  v_exp_f32 v127, v127
  v_cvt_pk_bf16_f32 v144, v124, v125
  v_cvt_pk_bf16_f32 v145, v126, v127
  v_mfma_f32_32x32x16_bf16 v[36:51], a[108:111], v[136:139], v[36:51]
  s_add_u32 s90, s90, 14336
  s_add_u32 m0, s94, 10240
  v_exp_f32 v128, v128
  v_exp_f32 v129, v129
  v_exp_f32 v130, v130
  v_exp_f32 v131, v131
  v_cvt_pk_bf16_f32 v146, v128, v129
  v_cvt_pk_bf16_f32 v147, v130, v131
  v_mfma_f32_32x32x16_bf16 v[116:131], a[112:115], v[92:95], 0
  buffer_load_dwordx4 v7, s[40:43], s90 offen lds
  buffer_load_dwordx4 v18, s[40:43], s90 offen offset:1024 lds
  v_exp_f32 v100, v100
  v_exp_f32 v101, v101
  v_exp_f32 v102, v102
  v_exp_f32 v103, v103
  v_cvt_pk_bf16_f32 v132, v100, v101
  v_cvt_pk_bf16_f32 v133, v102, v103
  v_mfma_f32_32x32x16_bf16 v[116:131], a[116:119], v[96:99], v[116:131]
  v_exp_f32 v104, v104
  v_exp_f32 v105, v105
  v_exp_f32 v106, v106
  v_exp_f32 v107, v107
  v_cvt_pk_bf16_f32 v134, v104, v105
  v_cvt_pk_bf16_f32 v135, v106, v107
  v_mfma_f32_32x32x16_bf16 v[52:67], a[120:123], v[140:143], v[52:67]
  v_exp_f32 v108, v108
  v_exp_f32 v109, v109
  v_exp_f32 v110, v110
  v_exp_f32 v111, v111
  v_cvt_pk_bf16_f32 v136, v108, v109
  v_cvt_pk_bf16_f32 v137, v110, v111
  v_mfma_f32_32x32x16_bf16 v[52:67], a[124:127], v[144:147], v[52:67]
  s_mov_b32 s98, 45056
  v_exp_f32 v112, v112
  v_exp_f32 v113, v113
  v_exp_f32 v114, v114
  v_exp_f32 v115, v115
  v_cvt_pk_bf16_f32 v138, v112, v113
  v_cvt_pk_bf16_f32 v139, v114, v115
  v_mfma_f32_32x32x16_bf16 v[100:115], a[112:115], v[68:71], 0
  buffer_load_dwordx4 a[176:179], v2, s[24:27], s98 offen offset:0 sc1
  buffer_load_dwordx4 a[180:183], v2, s[24:27], s98 offen offset:1024 sc1
  v_exp_f32 v116, v116
  v_exp_f32 v117, v117
  v_exp_f32 v118, v118
  v_exp_f32 v119, v119
  v_cvt_pk_bf16_f32 v140, v116, v117
  v_cvt_pk_bf16_f32 v141, v118, v119
  v_mfma_f32_32x32x16_bf16 v[100:115], a[116:119], v[72:75], v[100:115]
  v_exp_f32 v120, v120
  v_exp_f32 v121, v121
  v_exp_f32 v122, v122
  v_exp_f32 v123, v123
  v_cvt_pk_bf16_f32 v142, v120, v121
  v_cvt_pk_bf16_f32 v143, v122, v123
  v_mfma_f32_32x32x16_bf16 v[148:163], a[120:123], v[132:135], v[148:163]
  v_exp_f32 v124, v124
  v_exp_f32 v125, v125
  v_exp_f32 v126, v126
  v_exp_f32 v127, v127
  v_cvt_pk_bf16_f32 v144, v124, v125
  v_cvt_pk_bf16_f32 v145, v126, v127
  v_mfma_f32_32x32x16_bf16 v[148:163], a[124:127], v[136:139], v[148:163]
  v_exp_f32 v128, v128
  v_exp_f32 v129, v129
  v_exp_f32 v130, v130
  v_exp_f32 v131, v131
  v_cvt_pk_bf16_f32 v146, v128, v129
  v_cvt_pk_bf16_f32 v147, v130, v131
  v_mfma_f32_32x32x16_bf16 v[116:131], a[128:131], v[76:79], 0
  buffer_load_dwordx4 a[184:187], v2, s[24:27], s98 offen offset:2048 sc1
  buffer_load_dwordx4 a[188:191], v2, s[24:27], s98 offen offset:3072 sc1
  v_exp_f32 v100, v100
  v_exp_f32 v101, v101
  v_exp_f32 v102, v102
  v_exp_f32 v103, v103
  v_cvt_pk_bf16_f32 v132, v100, v101
  v_cvt_pk_bf16_f32 v133, v102, v103
  v_mfma_f32_32x32x16_bf16 v[116:131], a[132:135], v[80:83], v[116:131]
  v_exp_f32 v104, v104
  v_exp_f32 v105, v105
  v_exp_f32 v106, v106
  v_exp_f32 v107, v107
  v_cvt_pk_bf16_f32 v134, v104, v105
  v_cvt_pk_bf16_f32 v135, v106, v107
  v_mfma_f32_32x32x16_bf16 v[164:179], a[120:123], v[140:143], v[164:179]
  v_exp_f32 v108, v108
  v_exp_f32 v109, v109
  v_exp_f32 v110, v110
  v_exp_f32 v111, v111
  v_cvt_pk_bf16_f32 v136, v108, v109
  v_cvt_pk_bf16_f32 v137, v110, v111
  v_mfma_f32_32x32x16_bf16 v[164:179], a[124:127], v[144:147], v[164:179]
  s_add_u32 s90, s90, 14336
  s_add_u32 m0, s94, 12288
  v_exp_f32 v112, v112
  v_exp_f32 v113, v113
  v_exp_f32 v114, v114
  v_exp_f32 v115, v115
  v_cvt_pk_bf16_f32 v138, v112, v113
  v_cvt_pk_bf16_f32 v139, v114, v115
  v_mfma_f32_32x32x16_bf16 v[100:115], a[128:131], v[84:87], 0
  buffer_load_dwordx4 v7, s[40:43], s90 offen lds
  buffer_load_dwordx4 v18, s[40:43], s90 offen offset:1024 lds
  v_exp_f32 v116, v116
  v_exp_f32 v117, v117
  v_exp_f32 v118, v118
  v_exp_f32 v119, v119
  v_cvt_pk_bf16_f32 v140, v116, v117
  v_cvt_pk_bf16_f32 v141, v118, v119
  v_mfma_f32_32x32x16_bf16 v[100:115], a[132:135], v[88:91], v[100:115]
  v_exp_f32 v120, v120
  v_exp_f32 v121, v121
  v_exp_f32 v122, v122
  v_exp_f32 v123, v123
  v_cvt_pk_bf16_f32 v142, v120, v121
  v_cvt_pk_bf16_f32 v143, v122, v123
  v_mfma_f32_32x32x16_bf16 v[36:51], a[120:123], v[132:135], v[36:51]
  v_exp_f32 v124, v124
  v_exp_f32 v125, v125
  v_exp_f32 v126, v126
  v_exp_f32 v127, v127
  v_cvt_pk_bf16_f32 v144, v124, v125
  v_cvt_pk_bf16_f32 v145, v126, v127
  v_mfma_f32_32x32x16_bf16 v[36:51], a[124:127], v[136:139], v[36:51]
  v_exp_f32 v128, v128
  v_exp_f32 v129, v129
  v_exp_f32 v130, v130
  v_exp_f32 v131, v131
  v_cvt_pk_bf16_f32 v146, v128, v129
  v_cvt_pk_bf16_f32 v147, v130, v131
  v_mfma_f32_32x32x16_bf16 v[116:131], a[128:131], v[92:95], 0
  v_exp_f32 v100, v100
  v_exp_f32 v101, v101
  v_exp_f32 v102, v102
  v_exp_f32 v103, v103
  v_cvt_pk_bf16_f32 v132, v100, v101
  v_cvt_pk_bf16_f32 v133, v102, v103
  v_mfma_f32_32x32x16_bf16 v[116:131], a[132:135], v[96:99], v[116:131]
  s_waitcnt vmcnt(27)
  v_exp_f32 v104, v104
  v_exp_f32 v105, v105
  v_exp_f32 v106, v106
  v_exp_f32 v107, v107
  v_cvt_pk_bf16_f32 v134, v104, v105
  v_cvt_pk_bf16_f32 v135, v106, v107
  v_mfma_f32_32x32x16_bf16 v[52:67], a[136:139], v[140:143], v[52:67]
  v_exp_f32 v108, v108
  v_exp_f32 v109, v109
  v_exp_f32 v110, v110
  v_exp_f32 v111, v111
  v_cvt_pk_bf16_f32 v136, v108, v109
  v_cvt_pk_bf16_f32 v137, v110, v111
  v_mfma_f32_32x32x16_bf16 v[52:67], a[140:143], v[144:147], v[52:67]
  s_mov_b32 s98, 49152
  v_exp_f32 v112, v112
  v_exp_f32 v113, v113
  v_exp_f32 v114, v114
  v_exp_f32 v115, v115
  v_cvt_pk_bf16_f32 v138, v112, v113
  v_cvt_pk_bf16_f32 v139, v114, v115
  v_mfma_f32_32x32x16_bf16 v[100:115], a[128:131], v[68:71], 0
  buffer_load_dwordx4 a[192:195], v2, s[24:27], s98 offen offset:0 sc1
  buffer_load_dwordx4 a[196:199], v2, s[24:27], s98 offen offset:1024 sc1
  v_exp_f32 v116, v116
  v_exp_f32 v117, v117
  v_exp_f32 v118, v118
  v_exp_f32 v119, v119
  v_cvt_pk_bf16_f32 v140, v116, v117
  v_cvt_pk_bf16_f32 v141, v118, v119
  v_mfma_f32_32x32x16_bf16 v[100:115], a[132:135], v[72:75], v[100:115]
  v_exp_f32 v120, v120
  v_exp_f32 v121, v121
  v_exp_f32 v122, v122
  v_exp_f32 v123, v123
  v_cvt_pk_bf16_f32 v142, v120, v121
  v_cvt_pk_bf16_f32 v143, v122, v123
  v_mfma_f32_32x32x16_bf16 v[148:163], a[136:139], v[132:135], v[148:163]
  v_exp_f32 v124, v124
  v_exp_f32 v125, v125
  v_exp_f32 v126, v126
  v_exp_f32 v127, v127
  v_cvt_pk_bf16_f32 v144, v124, v125
  v_cvt_pk_bf16_f32 v145, v126, v127
  v_mfma_f32_32x32x16_bf16 v[148:163], a[140:143], v[136:139], v[148:163]
  s_waitcnt vmcnt(23)
  v_exp_f32 v128, v128
  v_exp_f32 v129, v129
  v_exp_f32 v130, v130
  v_exp_f32 v131, v131
  v_cvt_pk_bf16_f32 v146, v128, v129
  v_cvt_pk_bf16_f32 v147, v130, v131
  v_mfma_f32_32x32x16_bf16 v[116:131], a[144:147], v[76:79], 0
  buffer_load_dwordx4 a[200:203], v2, s[24:27], s98 offen offset:2048 sc1
  buffer_load_dwordx4 a[204:207], v2, s[24:27], s98 offen offset:3072 sc1
  v_exp_f32 v100, v100
  v_exp_f32 v101, v101
  v_exp_f32 v102, v102
  v_exp_f32 v103, v103
  v_cvt_pk_bf16_f32 v132, v100, v101
  v_cvt_pk_bf16_f32 v133, v102, v103
  v_mfma_f32_32x32x16_bf16 v[116:131], a[148:151], v[80:83], v[116:131]
  v_exp_f32 v104, v104
  v_exp_f32 v105, v105
  v_exp_f32 v106, v106
  v_exp_f32 v107, v107
  v_cvt_pk_bf16_f32 v134, v104, v105
  v_cvt_pk_bf16_f32 v135, v106, v107
  s_mov_b64 exec, 0xff
  buffer_load_dwordx4 v[180:183], v9, s[32:35], 0 offen sc1
  s_mov_b64 exec, -1
  v_mfma_f32_32x32x16_bf16 v[164:179], a[136:139], v[140:143], v[164:179]
  v_exp_f32 v108, v108
  v_exp_f32 v109, v109
  v_exp_f32 v110, v110
  v_exp_f32 v111, v111
  v_cvt_pk_bf16_f32 v136, v108, v109
  v_cvt_pk_bf16_f32 v137, v110, v111
  v_mfma_f32_32x32x16_bf16 v[164:179], a[140:143], v[144:147], v[164:179]
  v_exp_f32 v112, v112
  v_exp_f32 v113, v113
  v_exp_f32 v114, v114
  v_exp_f32 v115, v115
  v_cvt_pk_bf16_f32 v138, v112, v113
  v_cvt_pk_bf16_f32 v139, v114, v115
  v_mfma_f32_32x32x16_bf16 v[100:115], a[144:147], v[84:87], 0
  v_exp_f32 v116, v116
  v_exp_f32 v117, v117
  v_exp_f32 v118, v118
  v_exp_f32 v119, v119
  v_cvt_pk_bf16_f32 v140, v116, v117
  v_cvt_pk_bf16_f32 v141, v118, v119
  v_mfma_f32_32x32x16_bf16 v[100:115], a[148:151], v[88:91], v[100:115]
  v_exp_f32 v120, v120
  v_exp_f32 v121, v121
  v_exp_f32 v122, v122
  v_exp_f32 v123, v123
  v_cvt_pk_bf16_f32 v142, v120, v121
  v_cvt_pk_bf16_f32 v143, v122, v123
  v_mfma_f32_32x32x16_bf16 v[36:51], a[136:139], v[132:135], v[36:51]
  v_exp_f32 v124, v124
  v_exp_f32 v125, v125
  v_exp_f32 v126, v126
  v_exp_f32 v127, v127
  v_cvt_pk_bf16_f32 v144, v124, v125
  v_cvt_pk_bf16_f32 v145, v126, v127
  v_mfma_f32_32x32x16_bf16 v[36:51], a[140:143], v[136:139], v[36:51]
  v_exp_f32 v128, v128
  v_exp_f32 v129, v129
  v_exp_f32 v130, v130
  v_exp_f32 v131, v131
  v_cvt_pk_bf16_f32 v146, v128, v129
  v_cvt_pk_bf16_f32 v147, v130, v131
  v_mfma_f32_32x32x16_bf16 v[116:131], a[144:147], v[92:95], 0
  v_exp_f32 v100, v100
  v_exp_f32 v101, v101
  v_exp_f32 v102, v102
  v_exp_f32 v103, v103
  v_cvt_pk_bf16_f32 v132, v100, v101
  v_cvt_pk_bf16_f32 v133, v102, v103
  v_mfma_f32_32x32x16_bf16 v[116:131], a[148:151], v[96:99], v[116:131]
  s_waitcnt vmcnt(24)
  v_exp_f32 v104, v104
  v_exp_f32 v105, v105
  v_exp_f32 v106, v106
  v_exp_f32 v107, v107
  v_cvt_pk_bf16_f32 v134, v104, v105
  v_cvt_pk_bf16_f32 v135, v106, v107
  v_mfma_f32_32x32x16_bf16 v[52:67], a[152:155], v[140:143], v[52:67]
  v_exp_f32 v108, v108
  v_exp_f32 v109, v109
  v_exp_f32 v110, v110
  v_exp_f32 v111, v111
  v_cvt_pk_bf16_f32 v136, v108, v109
  v_cvt_pk_bf16_f32 v137, v110, v111
  v_mfma_f32_32x32x16_bf16 v[52:67], a[156:159], v[144:147], v[52:67]
  s_mov_b32 s98, 53248
  v_exp_f32 v112, v112
  v_exp_f32 v113, v113
  v_exp_f32 v114, v114
  v_exp_f32 v115, v115
  v_cvt_pk_bf16_f32 v138, v112, v113
  v_cvt_pk_bf16_f32 v139, v114, v115
  v_mfma_f32_32x32x16_bf16 v[100:115], a[144:147], v[68:71], 0
  buffer_load_dwordx4 a[208:211], v2, s[24:27], s98 offen offset:0 sc1
  buffer_load_dwordx4 a[212:215], v2, s[24:27], s98 offen offset:1024 sc1
  v_exp_f32 v116, v116
  v_exp_f32 v117, v117
  v_exp_f32 v118, v118
  v_exp_f32 v119, v119
  v_cvt_pk_bf16_f32 v140, v116, v117
  v_cvt_pk_bf16_f32 v141, v118, v119
  v_mfma_f32_32x32x16_bf16 v[100:115], a[148:151], v[72:75], v[100:115]
  v_exp_f32 v120, v120
  v_exp_f32 v121, v121
  v_exp_f32 v122, v122
  v_exp_f32 v123, v123
  v_cvt_pk_bf16_f32 v142, v120, v121
  v_cvt_pk_bf16_f32 v143, v122, v123
  v_mfma_f32_32x32x16_bf16 v[148:163], a[152:155], v[132:135], v[148:163]
  v_exp_f32 v124, v124
  v_exp_f32 v125, v125
  v_exp_f32 v126, v126
  v_exp_f32 v127, v127
  v_cvt_pk_bf16_f32 v144, v124, v125
  v_cvt_pk_bf16_f32 v145, v126, v127
  v_mfma_f32_32x32x16_bf16 v[148:163], a[156:159], v[136:139], v[148:163]
  s_waitcnt vmcnt(20)
  v_exp_f32 v128, v128
  v_exp_f32 v129, v129
  v_exp_f32 v130, v130
  v_exp_f32 v131, v131
  v_cvt_pk_bf16_f32 v146, v128, v129
  v_cvt_pk_bf16_f32 v147, v130, v131
  v_mfma_f32_32x32x16_bf16 v[116:131], a[160:163], v[76:79], 0
  buffer_load_dwordx4 a[216:219], v2, s[24:27], s98 offen offset:2048 sc1
  buffer_load_dwordx4 a[220:223], v2, s[24:27], s98 offen offset:3072 sc1
  v_exp_f32 v100, v100
  v_exp_f32 v101, v101
  v_exp_f32 v102, v102
  v_exp_f32 v103, v103
  v_cvt_pk_bf16_f32 v132, v100, v101
  v_cvt_pk_bf16_f32 v133, v102, v103
  v_mfma_f32_32x32x16_bf16 v[116:131], a[164:167], v[80:83], v[116:131]
  v_exp_f32 v104, v104
  v_exp_f32 v105, v105
  v_exp_f32 v106, v106
  v_exp_f32 v107, v107
  v_cvt_pk_bf16_f32 v134, v104, v105
  v_cvt_pk_bf16_f32 v135, v106, v107
  v_mfma_f32_32x32x16_bf16 v[164:179], a[152:155], v[140:143], v[164:179]
  v_exp_f32 v108, v108
  v_exp_f32 v109, v109
  v_exp_f32 v110, v110
  v_exp_f32 v111, v111
  v_cvt_pk_bf16_f32 v136, v108, v109
  v_cvt_pk_bf16_f32 v137, v110, v111
  v_mfma_f32_32x32x16_bf16 v[164:179], a[156:159], v[144:147], v[164:179]
  v_exp_f32 v112, v112
  v_exp_f32 v113, v113
  v_exp_f32 v114, v114
  v_exp_f32 v115, v115
  v_cvt_pk_bf16_f32 v138, v112, v113
  v_cvt_pk_bf16_f32 v139, v114, v115
  v_mfma_f32_32x32x16_bf16 v[100:115], a[160:163], v[84:87], 0
  v_exp_f32 v116, v116
  v_exp_f32 v117, v117
  v_exp_f32 v118, v118
  v_exp_f32 v119, v119
  v_cvt_pk_bf16_f32 v140, v116, v117
  v_cvt_pk_bf16_f32 v141, v118, v119
  v_mfma_f32_32x32x16_bf16 v[100:115], a[164:167], v[88:91], v[100:115]
  v_exp_f32 v120, v120
  v_exp_f32 v121, v121
  v_exp_f32 v122, v122
  v_exp_f32 v123, v123
  v_cvt_pk_bf16_f32 v142, v120, v121
  v_cvt_pk_bf16_f32 v143, v122, v123
  s_waitcnt vmcnt(4)
  s_mov_b64 exec, 0xff
  v_xor_b32 v188, s66, v180
  v_xor_b32 v181, s66, v181
  v_xor_b32 v182, s66, v182
  v_xor_b32 v183, s66, v183
  v_or3_b32 v188, v188, v181, v182
  v_or_b32 v188, v188, v183
  v_cmp_ne_u32 vcc, 0, v188
  s_mov_b32 s73, 0
  s_cbranch_vccz L_poAd_11
  buffer_load_dwordx4 v[180:183], v9, s[32:35], 0 offen sc1
L_poA_10:
  buffer_load_dwordx4 v[184:187], v9, s[32:35], 0 offen sc1
  s_waitcnt vmcnt(1)
  v_xor_b32 v188, s66, v180
  v_xor_b32 v181, s66, v181
  v_xor_b32 v182, s66, v182
  v_xor_b32 v183, s66, v183
  v_or3_b32 v188, v188, v181, v182
  v_or_b32 v188, v188, v183
  v_cmp_ne_u32 vcc, 0, v188
  s_add_u32 s73, s73, 1
  s_cbranch_vccz L_poAd_11
  buffer_load_dwordx4 v[180:183], v9, s[32:35], 0 offen sc1
  s_waitcnt vmcnt(1)
  v_xor_b32 v188, s66, v184
  v_xor_b32 v185, s66, v185
  v_xor_b32 v186, s66, v186
  v_xor_b32 v187, s66, v187
  v_or3_b32 v188, v188, v185, v186
  v_or_b32 v188, v188, v187
  v_cmp_ne_u32 vcc, 0, v188
  s_cmp_gt_u32 s73, 262144
  s_cbranch_scc1 L_poAd_11
  s_cbranch_vccnz L_poA_10
L_poAd_11:
  s_mov_b64 exec, -1
  v_mfma_f32_32x32x16_bf16 v[36:51], a[152:155], v[132:135], v[36:51]
  v_exp_f32 v124, v124
  v_exp_f32 v125, v125
  v_exp_f32 v126, v126
  v_exp_f32 v127, v127
  v_cvt_pk_bf16_f32 v144, v124, v125
  v_cvt_pk_bf16_f32 v145, v126, v127
  v_mfma_f32_32x32x16_bf16 v[36:51], a[156:159], v[136:139], v[36:51]
  s_lshl_b32 s52, s75, 1
  s_lshr_b32 s53, s48, 1
  s_add_u32 s68, s52, s53
  s_lshl_b32 s91, s68, 15
  s_add_u32 s91, s91, 10485760
  v_exp_f32 v128, v128
  v_exp_f32 v129, v129
  v_exp_f32 v130, v130
  v_exp_f32 v131, v131
  v_cvt_pk_bf16_f32 v146, v128, v129
  v_cvt_pk_bf16_f32 v147, v130, v131
  v_mfma_f32_32x32x16_bf16 v[116:131], a[160:163], v[92:95], 0
  buffer_load_dwordx4 a[0:3], v2, s[32:35], s91 offen offset:0 sc1
  buffer_load_dwordx4 a[4:7], v2, s[32:35], s91 offen offset:1024 sc1
  v_exp_f32 v100, v100
  v_exp_f32 v101, v101
  v_exp_f32 v102, v102
  v_exp_f32 v103, v103
  v_cvt_pk_bf16_f32 v132, v100, v101
  v_cvt_pk_bf16_f32 v133, v102, v103
  v_mfma_f32_32x32x16_bf16 v[116:131], a[164:167], v[96:99], v[116:131]
  v_exp_f32 v104, v104
  v_exp_f32 v105, v105
  v_exp_f32 v106, v106
  v_exp_f32 v107, v107
  v_cvt_pk_bf16_f32 v134, v104, v105
  v_cvt_pk_bf16_f32 v135, v106, v107
  v_mfma_f32_32x32x16_bf16 v[52:67], a[168:171], v[140:143], v[52:67]
  v_exp_f32 v108, v108
  v_exp_f32 v109, v109
  v_exp_f32 v110, v110
  v_exp_f32 v111, v111
  v_cvt_pk_bf16_f32 v136, v108, v109
  v_cvt_pk_bf16_f32 v137, v110, v111
  v_mfma_f32_32x32x16_bf16 v[52:67], a[172:175], v[144:147], v[52:67]
  v_exp_f32 v112, v112
  v_exp_f32 v113, v113
  v_exp_f32 v114, v114
  v_exp_f32 v115, v115
  v_cvt_pk_bf16_f32 v138, v112, v113
  v_cvt_pk_bf16_f32 v139, v114, v115
  v_mfma_f32_32x32x16_bf16 v[100:115], a[160:163], v[68:71], 0
  buffer_load_dwordx4 a[8:11], v2, s[32:35], s91 offen offset:2048 sc1
  buffer_load_dwordx4 a[12:15], v2, s[32:35], s91 offen offset:3072 sc1
  v_exp_f32 v116, v116
  v_exp_f32 v117, v117
  v_exp_f32 v118, v118
  v_exp_f32 v119, v119
  v_cvt_pk_bf16_f32 v140, v116, v117
  v_cvt_pk_bf16_f32 v141, v118, v119
  v_mfma_f32_32x32x16_bf16 v[100:115], a[164:167], v[72:75], v[100:115]
  v_exp_f32 v120, v120
  v_exp_f32 v121, v121
  v_exp_f32 v122, v122
  v_exp_f32 v123, v123
  v_cvt_pk_bf16_f32 v142, v120, v121
  v_cvt_pk_bf16_f32 v143, v122, v123
  v_mfma_f32_32x32x16_bf16 v[148:163], a[168:171], v[132:135], v[148:163]
  v_exp_f32 v124, v124
  v_exp_f32 v125, v125
  v_exp_f32 v126, v126
  v_exp_f32 v127, v127
  v_cvt_pk_bf16_f32 v144, v124, v125
  v_cvt_pk_bf16_f32 v145, v126, v127
  v_mfma_f32_32x32x16_bf16 v[148:163], a[172:175], v[136:139], v[148:163]
  s_add_u32 s91, s91, 4096
  v_exp_f32 v128, v128
  v_exp_f32 v129, v129
  v_exp_f32 v130, v130
  v_exp_f32 v131, v131
  v_cvt_pk_bf16_f32 v146, v128, v129
  v_cvt_pk_bf16_f32 v147, v130, v131
  v_mfma_f32_32x32x16_bf16 v[116:131], a[176:179], v[76:79], 0
  buffer_load_dwordx4 a[16:19], v2, s[32:35], s91 offen offset:0 sc1
  buffer_load_dwordx4 a[20:23], v2, s[32:35], s91 offen offset:1024 sc1
  v_exp_f32 v100, v100
  v_exp_f32 v101, v101
  v_exp_f32 v102, v102
  v_exp_f32 v103, v103
  v_cvt_pk_bf16_f32 v132, v100, v101
  v_cvt_pk_bf16_f32 v133, v102, v103
  v_mfma_f32_32x32x16_bf16 v[116:131], a[180:183], v[80:83], v[116:131]
  v_exp_f32 v104, v104
  v_exp_f32 v105, v105
  v_exp_f32 v106, v106
  v_exp_f32 v107, v107
  v_cvt_pk_bf16_f32 v134, v104, v105
  v_cvt_pk_bf16_f32 v135, v106, v107
  v_mfma_f32_32x32x16_bf16 v[164:179], a[168:171], v[140:143], v[164:179]
  v_exp_f32 v108, v108
  v_exp_f32 v109, v109
  v_exp_f32 v110, v110
  v_exp_f32 v111, v111
  v_cvt_pk_bf16_f32 v136, v108, v109
  v_cvt_pk_bf16_f32 v137, v110, v111
  v_mfma_f32_32x32x16_bf16 v[164:179], a[172:175], v[144:147], v[164:179]
  v_exp_f32 v112, v112
  v_exp_f32 v113, v113
  v_exp_f32 v114, v114
  v_exp_f32 v115, v115
  v_cvt_pk_bf16_f32 v138, v112, v113
  v_cvt_pk_bf16_f32 v139, v114, v115
  v_mfma_f32_32x32x16_bf16 v[100:115], a[176:179], v[84:87], 0
  buffer_load_dwordx4 a[24:27], v2, s[32:35], s91 offen offset:2048 sc1
  buffer_load_dwordx4 a[28:31], v2, s[32:35], s91 offen offset:3072 sc1
  v_exp_f32 v116, v116
  v_exp_f32 v117, v117
  v_exp_f32 v118, v118
  v_exp_f32 v119, v119
  v_cvt_pk_bf16_f32 v140, v116, v117
  v_cvt_pk_bf16_f32 v141, v118, v119
  v_mfma_f32_32x32x16_bf16 v[100:115], a[180:183], v[88:91], v[100:115]
  v_exp_f32 v120, v120
  v_exp_f32 v121, v121
  v_exp_f32 v122, v122
  v_exp_f32 v123, v123
  v_cvt_pk_bf16_f32 v142, v120, v121
  v_cvt_pk_bf16_f32 v143, v122, v123
  v_mfma_f32_32x32x16_bf16 v[36:51], a[168:171], v[132:135], v[36:51]
  v_exp_f32 v124, v124
  v_exp_f32 v125, v125
  v_exp_f32 v126, v126
  v_exp_f32 v127, v127
  v_cvt_pk_bf16_f32 v144, v124, v125
  v_cvt_pk_bf16_f32 v145, v126, v127
  v_mfma_f32_32x32x16_bf16 v[36:51], a[172:175], v[136:139], v[36:51]
  s_mov_b32 s98, 57344
  v_exp_f32 v128, v128
  v_exp_f32 v129, v129
  v_exp_f32 v130, v130
  v_exp_f32 v131, v131
  v_cvt_pk_bf16_f32 v146, v128, v129
  v_cvt_pk_bf16_f32 v147, v130, v131
  v_mfma_f32_32x32x16_bf16 v[116:131], a[176:179], v[92:95], 0
  buffer_load_dwordx4 a[224:227], v2, s[24:27], s98 offen offset:0 sc1
  buffer_load_dwordx4 a[228:231], v2, s[24:27], s98 offen offset:1024 sc1
  v_exp_f32 v100, v100
  v_exp_f32 v101, v101
  v_exp_f32 v102, v102
  v_exp_f32 v103, v103
  v_cvt_pk_bf16_f32 v132, v100, v101
  v_cvt_pk_bf16_f32 v133, v102, v103
  v_mfma_f32_32x32x16_bf16 v[116:131], a[180:183], v[96:99], v[116:131]
  v_exp_f32 v104, v104
  v_exp_f32 v105, v105
  v_exp_f32 v106, v106
  v_exp_f32 v107, v107
  v_cvt_pk_bf16_f32 v134, v104, v105
  v_cvt_pk_bf16_f32 v135, v106, v107
  v_mfma_f32_32x32x16_bf16 v[52:67], a[184:187], v[140:143], v[52:67]
  v_exp_f32 v108, v108
  v_exp_f32 v109, v109
  v_exp_f32 v110, v110
  v_exp_f32 v111, v111
  v_cvt_pk_bf16_f32 v136, v108, v109
  v_cvt_pk_bf16_f32 v137, v110, v111
  v_mfma_f32_32x32x16_bf16 v[52:67], a[188:191], v[144:147], v[52:67]
  s_add_u32 s91, s91, 4096
  v_exp_f32 v112, v112
  v_exp_f32 v113, v113
  v_exp_f32 v114, v114
  v_exp_f32 v115, v115
  v_cvt_pk_bf16_f32 v138, v112, v113
  v_cvt_pk_bf16_f32 v139, v114, v115
  v_mfma_f32_32x32x16_bf16 v[100:115], a[176:179], v[68:71], 0
  buffer_load_dwordx4 a[32:35], v2, s[32:35], s91 offen offset:0 sc1
  buffer_load_dwordx4 a[36:39], v2, s[32:35], s91 offen offset:1024 sc1
  v_exp_f32 v116, v116
  v_exp_f32 v117, v117
  v_exp_f32 v118, v118
  v_exp_f32 v119, v119
  v_cvt_pk_bf16_f32 v140, v116, v117
  v_cvt_pk_bf16_f32 v141, v118, v119
  v_mfma_f32_32x32x16_bf16 v[100:115], a[180:183], v[72:75], v[100:115]
  v_exp_f32 v120, v120
  v_exp_f32 v121, v121
  v_exp_f32 v122, v122
  v_exp_f32 v123, v123
  v_cvt_pk_bf16_f32 v142, v120, v121
  v_cvt_pk_bf16_f32 v143, v122, v123
  v_mfma_f32_32x32x16_bf16 v[148:163], a[184:187], v[132:135], v[148:163]
  v_exp_f32 v124, v124
  v_exp_f32 v125, v125
  v_exp_f32 v126, v126
  v_exp_f32 v127, v127
  v_cvt_pk_bf16_f32 v144, v124, v125
  v_cvt_pk_bf16_f32 v145, v126, v127
  v_mfma_f32_32x32x16_bf16 v[148:163], a[188:191], v[136:139], v[148:163]
  v_exp_f32 v128, v128
  v_exp_f32 v129, v129
  v_exp_f32 v130, v130
  v_exp_f32 v131, v131
  v_cvt_pk_bf16_f32 v146, v128, v129
  v_cvt_pk_bf16_f32 v147, v130, v131
  v_mfma_f32_32x32x16_bf16 v[116:131], a[192:195], v[76:79], 0
  buffer_load_dwordx4 a[232:235], v2, s[24:27], s98 offen offset:2048 sc1
  buffer_load_dwordx4 a[236:239], v2, s[24:27], s98 offen offset:3072 sc1
  v_exp_f32 v100, v100
  v_exp_f32 v101, v101
  v_exp_f32 v102, v102
  v_exp_f32 v103, v103
  v_cvt_pk_bf16_f32 v132, v100, v101
  v_cvt_pk_bf16_f32 v133, v102, v103
  v_mfma_f32_32x32x16_bf16 v[116:131], a[196:199], v[80:83], v[116:131]
  v_exp_f32 v104, v104
  v_exp_f32 v105, v105
  v_exp_f32 v106, v106
  v_exp_f32 v107, v107
  v_cvt_pk_bf16_f32 v134, v104, v105
  v_cvt_pk_bf16_f32 v135, v106, v107
  v_mfma_f32_32x32x16_bf16 v[164:179], a[184:187], v[140:143], v[164:179]
  v_exp_f32 v108, v108
  v_exp_f32 v109, v109
  v_exp_f32 v110, v110
  v_exp_f32 v111, v111
  v_cvt_pk_bf16_f32 v136, v108, v109
  v_cvt_pk_bf16_f32 v137, v110, v111
  v_mfma_f32_32x32x16_bf16 v[164:179], a[188:191], v[144:147], v[164:179]
  v_exp_f32 v112, v112
  v_exp_f32 v113, v113
  v_exp_f32 v114, v114
  v_exp_f32 v115, v115
  v_cvt_pk_bf16_f32 v138, v112, v113
  v_cvt_pk_bf16_f32 v139, v114, v115
  v_mfma_f32_32x32x16_bf16 v[100:115], a[192:195], v[84:87], 0
  buffer_load_dwordx4 a[40:43], v2, s[32:35], s91 offen offset:2048 sc1
  buffer_load_dwordx4 a[44:47], v2, s[32:35], s91 offen offset:3072 sc1
  v_exp_f32 v116, v116
  v_exp_f32 v117, v117
  v_exp_f32 v118, v118
  v_exp_f32 v119, v119
  v_cvt_pk_bf16_f32 v140, v116, v117
  v_cvt_pk_bf16_f32 v141, v118, v119
  v_mfma_f32_32x32x16_bf16 v[100:115], a[196:199], v[88:91], v[100:115]
  v_exp_f32 v120, v120
  v_exp_f32 v121, v121
  v_exp_f32 v122, v122
  v_exp_f32 v123, v123
  v_cvt_pk_bf16_f32 v142, v120, v121
  v_cvt_pk_bf16_f32 v143, v122, v123
  v_mfma_f32_32x32x16_bf16 v[36:51], a[184:187], v[132:135], v[36:51]
  v_exp_f32 v124, v124
  v_exp_f32 v125, v125
  v_exp_f32 v126, v126
  v_exp_f32 v127, v127
  v_cvt_pk_bf16_f32 v144, v124, v125
  v_cvt_pk_bf16_f32 v145, v126, v127
  v_mfma_f32_32x32x16_bf16 v[36:51], a[188:191], v[136:139], v[36:51]
  s_mov_b32 s98, 61440
  v_exp_f32 v128, v128
  v_exp_f32 v129, v129
  v_exp_f32 v130, v130
  v_exp_f32 v131, v131
  v_cvt_pk_bf16_f32 v146, v128, v129
  v_cvt_pk_bf16_f32 v147, v130, v131
  v_mfma_f32_32x32x16_bf16 v[116:131], a[192:195], v[92:95], 0
  buffer_load_dwordx4 a[240:243], v2, s[24:27], s98 offen offset:0 sc1
  buffer_load_dwordx4 a[244:247], v2, s[24:27], s98 offen offset:1024 sc1
  v_exp_f32 v100, v100
  v_exp_f32 v101, v101
  v_exp_f32 v102, v102
  v_exp_f32 v103, v103
  v_cvt_pk_bf16_f32 v132, v100, v101
  v_cvt_pk_bf16_f32 v133, v102, v103
  v_mfma_f32_32x32x16_bf16 v[116:131], a[196:199], v[96:99], v[116:131]
  v_exp_f32 v104, v104
  v_exp_f32 v105, v105
  v_exp_f32 v106, v106
  v_exp_f32 v107, v107
  v_cvt_pk_bf16_f32 v134, v104, v105
  v_cvt_pk_bf16_f32 v135, v106, v107
  v_mfma_f32_32x32x16_bf16 v[52:67], a[200:203], v[140:143], v[52:67]
  v_exp_f32 v108, v108
  v_exp_f32 v109, v109
  v_exp_f32 v110, v110
  v_exp_f32 v111, v111
  v_cvt_pk_bf16_f32 v136, v108, v109
  v_cvt_pk_bf16_f32 v137, v110, v111
  v_mfma_f32_32x32x16_bf16 v[52:67], a[204:207], v[144:147], v[52:67]
  s_add_u32 s91, s91, 4096
  v_exp_f32 v112, v112
  v_exp_f32 v113, v113
  v_exp_f32 v114, v114
  v_exp_f32 v115, v115
  v_cvt_pk_bf16_f32 v138, v112, v113
  v_cvt_pk_bf16_f32 v139, v114, v115
  v_mfma_f32_32x32x16_bf16 v[100:115], a[192:195], v[68:71], 0
  buffer_load_dwordx4 a[48:51], v2, s[32:35], s91 offen offset:0 sc1
  buffer_load_dwordx4 a[52:55], v2, s[32:35], s91 offen offset:1024 sc1
  v_exp_f32 v116, v116
  v_exp_f32 v117, v117
  v_exp_f32 v118, v118
  v_exp_f32 v119, v119
  v_cvt_pk_bf16_f32 v140, v116, v117
  v_cvt_pk_bf16_f32 v141, v118, v119
  v_mfma_f32_32x32x16_bf16 v[100:115], a[196:199], v[72:75], v[100:115]
  v_exp_f32 v120, v120
  v_exp_f32 v121, v121
  v_exp_f32 v122, v122
  v_exp_f32 v123, v123
  v_cvt_pk_bf16_f32 v142, v120, v121
  v_cvt_pk_bf16_f32 v143, v122, v123
  v_mfma_f32_32x32x16_bf16 v[148:163], a[200:203], v[132:135], v[148:163]
  v_exp_f32 v124, v124
  v_exp_f32 v125, v125
  v_exp_f32 v126, v126
  v_exp_f32 v127, v127
  v_cvt_pk_bf16_f32 v144, v124, v125
  v_cvt_pk_bf16_f32 v145, v126, v127
  v_mfma_f32_32x32x16_bf16 v[148:163], a[204:207], v[136:139], v[148:163]
  s_waitcnt vmcnt(22)
  v_exp_f32 v128, v128
  v_exp_f32 v129, v129
  v_exp_f32 v130, v130
  v_exp_f32 v131, v131
  v_cvt_pk_bf16_f32 v146, v128, v129
  v_cvt_pk_bf16_f32 v147, v130, v131
  v_mfma_f32_32x32x16_bf16 v[116:131], a[208:211], v[76:79], 0
  buffer_load_dwordx4 a[248:251], v2, s[24:27], s98 offen offset:2048 sc1
  buffer_load_dwordx4 a[252:255], v2, s[24:27], s98 offen offset:3072 sc1
  v_exp_f32 v100, v100
  v_exp_f32 v101, v101
  v_exp_f32 v102, v102
  v_exp_f32 v103, v103
  v_cvt_pk_bf16_f32 v132, v100, v101
  v_cvt_pk_bf16_f32 v133, v102, v103
  v_mfma_f32_32x32x16_bf16 v[116:131], a[212:215], v[80:83], v[116:131]
  v_exp_f32 v104, v104
  v_exp_f32 v105, v105
  v_exp_f32 v106, v106
  v_exp_f32 v107, v107
  v_cvt_pk_bf16_f32 v134, v104, v105
  v_cvt_pk_bf16_f32 v135, v106, v107
  v_mfma_f32_32x32x16_bf16 v[164:179], a[200:203], v[140:143], v[164:179]
  v_exp_f32 v108, v108
  v_exp_f32 v109, v109
  v_exp_f32 v110, v110
  v_exp_f32 v111, v111
  v_cvt_pk_bf16_f32 v136, v108, v109
  v_cvt_pk_bf16_f32 v137, v110, v111
  v_mfma_f32_32x32x16_bf16 v[164:179], a[204:207], v[144:147], v[164:179]
  v_exp_f32 v112, v112
  v_exp_f32 v113, v113
  v_exp_f32 v114, v114
  v_exp_f32 v115, v115
  v_cvt_pk_bf16_f32 v138, v112, v113
  v_cvt_pk_bf16_f32 v139, v114, v115
  v_mfma_f32_32x32x16_bf16 v[100:115], a[208:211], v[84:87], 0
  buffer_load_dwordx4 a[56:59], v2, s[32:35], s91 offen offset:2048 sc1
  buffer_load_dwordx4 a[60:63], v2, s[32:35], s91 offen offset:3072 sc1
  v_exp_f32 v116, v116
  v_exp_f32 v117, v117
  v_exp_f32 v118, v118
  v_exp_f32 v119, v119
  v_cvt_pk_bf16_f32 v140, v116, v117
  v_cvt_pk_bf16_f32 v141, v118, v119
  v_mfma_f32_32x32x16_bf16 v[100:115], a[212:215], v[88:91], v[100:115]
  v_exp_f32 v120, v120
  v_exp_f32 v121, v121
  v_exp_f32 v122, v122
  v_exp_f32 v123, v123
  v_cvt_pk_bf16_f32 v142, v120, v121
  v_cvt_pk_bf16_f32 v143, v122, v123
  v_mfma_f32_32x32x16_bf16 v[36:51], a[200:203], v[132:135], v[36:51]
  v_exp_f32 v124, v124
  v_exp_f32 v125, v125
  v_exp_f32 v126, v126
  v_exp_f32 v127, v127
  v_cvt_pk_bf16_f32 v144, v124, v125
  v_cvt_pk_bf16_f32 v145, v126, v127
  v_mfma_f32_32x32x16_bf16 v[36:51], a[204:207], v[136:139], v[36:51]
  s_add_u32 s91, s91, 4096
  v_exp_f32 v128, v128
  v_exp_f32 v129, v129
  v_exp_f32 v130, v130
  v_exp_f32 v131, v131
  v_cvt_pk_bf16_f32 v146, v128, v129
  v_cvt_pk_bf16_f32 v147, v130, v131
  v_mfma_f32_32x32x16_bf16 v[116:131], a[208:211], v[92:95], 0
  buffer_load_dwordx4 a[64:67], v2, s[32:35], s91 offen offset:0 sc1
  buffer_load_dwordx4 a[68:71], v2, s[32:35], s91 offen offset:1024 sc1
  v_exp_f32 v100, v100
  v_exp_f32 v101, v101
  v_exp_f32 v102, v102
  v_exp_f32 v103, v103
  v_cvt_pk_bf16_f32 v132, v100, v101
  v_cvt_pk_bf16_f32 v133, v102, v103
  v_mfma_f32_32x32x16_bf16 v[116:131], a[212:215], v[96:99], v[116:131]
  s_waitcnt vmcnt(26)
  v_exp_f32 v104, v104
  v_exp_f32 v105, v105
  v_exp_f32 v106, v106
  v_exp_f32 v107, v107
  v_cvt_pk_bf16_f32 v134, v104, v105
  v_cvt_pk_bf16_f32 v135, v106, v107
  v_mfma_f32_32x32x16_bf16 v[52:67], a[216:219], v[140:143], v[52:67]
  v_exp_f32 v108, v108
  v_exp_f32 v109, v109
  v_exp_f32 v110, v110
  v_exp_f32 v111, v111
  v_cvt_pk_bf16_f32 v136, v108, v109
  v_cvt_pk_bf16_f32 v137, v110, v111
  v_mfma_f32_32x32x16_bf16 v[52:67], a[220:223], v[144:147], v[52:67]
  v_exp_f32 v112, v112
  v_exp_f32 v113, v113
  v_exp_f32 v114, v114
  v_exp_f32 v115, v115
  v_cvt_pk_bf16_f32 v138, v112, v113
  v_cvt_pk_bf16_f32 v139, v114, v115
  v_mfma_f32_32x32x16_bf16 v[100:115], a[208:211], v[68:71], 0
  buffer_load_dwordx4 a[72:75], v2, s[32:35], s91 offen offset:2048 sc1
  buffer_load_dwordx4 a[76:79], v2, s[32:35], s91 offen offset:3072 sc1
  v_exp_f32 v116, v116
  v_exp_f32 v117, v117
  v_exp_f32 v118, v118
  v_exp_f32 v119, v119
  v_cvt_pk_bf16_f32 v140, v116, v117
  v_cvt_pk_bf16_f32 v141, v118, v119
  v_mfma_f32_32x32x16_bf16 v[100:115], a[212:215], v[72:75], v[100:115]
  v_exp_f32 v120, v120
  v_exp_f32 v121, v121
  v_exp_f32 v122, v122
  v_exp_f32 v123, v123
  v_cvt_pk_bf16_f32 v142, v120, v121
  v_cvt_pk_bf16_f32 v143, v122, v123
  v_mfma_f32_32x32x16_bf16 v[148:163], a[216:219], v[132:135], v[148:163]
  v_exp_f32 v124, v124
  v_exp_f32 v125, v125
  v_exp_f32 v126, v126
  v_exp_f32 v127, v127
  v_cvt_pk_bf16_f32 v144, v124, v125
  v_cvt_pk_bf16_f32 v145, v126, v127
  v_mfma_f32_32x32x16_bf16 v[148:163], a[220:223], v[136:139], v[148:163]
  s_waitcnt vmcnt(18)
  s_add_u32 s91, s91, 4096
  v_exp_f32 v128, v128
  v_exp_f32 v129, v129
  v_exp_f32 v130, v130
  v_exp_f32 v131, v131
  v_cvt_pk_bf16_f32 v146, v128, v129
  v_cvt_pk_bf16_f32 v147, v130, v131
  v_mfma_f32_32x32x16_bf16 v[116:131], a[224:227], v[76:79], 0
  buffer_load_dwordx4 a[80:83], v2, s[32:35], s91 offen offset:0 sc1
  buffer_load_dwordx4 a[84:87], v2, s[32:35], s91 offen offset:1024 sc1
  v_exp_f32 v100, v100
  v_exp_f32 v101, v101
  v_exp_f32 v102, v102
  v_exp_f32 v103, v103
  v_cvt_pk_bf16_f32 v132, v100, v101
  v_cvt_pk_bf16_f32 v133, v102, v103
  v_mfma_f32_32x32x16_bf16 v[116:131], a[228:231], v[80:83], v[116:131]
  v_exp_f32 v104, v104
  v_exp_f32 v105, v105
  v_exp_f32 v106, v106
  v_exp_f32 v107, v107
  v_cvt_pk_bf16_f32 v134, v104, v105
  v_cvt_pk_bf16_f32 v135, v106, v107
  v_mfma_f32_32x32x16_bf16 v[164:179], a[216:219], v[140:143], v[164:179]
  v_exp_f32 v108, v108
  v_exp_f32 v109, v109
  v_exp_f32 v110, v110
  v_exp_f32 v111, v111
  v_cvt_pk_bf16_f32 v136, v108, v109
  v_cvt_pk_bf16_f32 v137, v110, v111
  v_mfma_f32_32x32x16_bf16 v[164:179], a[220:223], v[144:147], v[164:179]
  v_exp_f32 v112, v112
  v_exp_f32 v113, v113
  v_exp_f32 v114, v114
  v_exp_f32 v115, v115
  v_cvt_pk_bf16_f32 v138, v112, v113
  v_cvt_pk_bf16_f32 v139, v114, v115
  v_mfma_f32_32x32x16_bf16 v[100:115], a[224:227], v[84:87], 0
  buffer_load_dwordx4 a[88:91], v2, s[32:35], s91 offen offset:2048 sc1
  buffer_load_dwordx4 a[92:95], v2, s[32:35], s91 offen offset:3072 sc1
  v_exp_f32 v116, v116
  v_exp_f32 v117, v117
  v_exp_f32 v118, v118
  v_exp_f32 v119, v119
  v_cvt_pk_bf16_f32 v140, v116, v117
  v_cvt_pk_bf16_f32 v141, v118, v119
  v_mfma_f32_32x32x16_bf16 v[100:115], a[228:231], v[88:91], v[100:115]
  v_exp_f32 v120, v120
  v_exp_f32 v121, v121
  v_exp_f32 v122, v122
  v_exp_f32 v123, v123
  v_cvt_pk_bf16_f32 v142, v120, v121
  v_cvt_pk_bf16_f32 v143, v122, v123
  s_add_u32 s52, s48, 1
  s_and_b32 s52, s52, 3
  s_mul_i32 s52, s52, 12288
  s_add_u32 s52, s52, 114688
  v_add_u32 v189, s52, v2
  s_add_u32 s52, s48, 2
  s_and_b32 s52, s52, 3
  s_mul_i32 s52, s52, 12288
  s_add_u32 s52, s52, 118784
  v_add_u32 v190, s52, v2
  s_add_u32 s52, s48, 3
  s_and_b32 s52, s52, 3
  s_mul_i32 s52, s52, 12288
  s_add_u32 s52, s52, 122880
  v_add_u32 v191, s52, v2
  s_mul_i32 s52, s48, 12288
  s_add_u32 s52, s52, 114688
  v_add_u32 v17, s52, v2
  v_mfma_f32_32x32x16_bf16 v[36:51], a[216:219], v[132:135], v[36:51]
  v_exp_f32 v124, v124
  v_exp_f32 v125, v125
  v_exp_f32 v126, v126
  v_exp_f32 v127, v127
  v_cvt_pk_bf16_f32 v144, v124, v125
  v_cvt_pk_bf16_f32 v145, v126, v127
  v_mfma_f32_32x32x16_bf16 v[36:51], a[220:223], v[136:139], v[36:51]
  s_add_u32 s91, s91, 4096
  v_exp_f32 v128, v128
  v_exp_f32 v129, v129
  v_exp_f32 v130, v130
  v_exp_f32 v131, v131
  v_cvt_pk_bf16_f32 v146, v128, v129
  v_cvt_pk_bf16_f32 v147, v130, v131
  v_mfma_f32_32x32x16_bf16 v[116:131], a[224:227], v[92:95], 0
  buffer_load_dwordx4 a[96:99], v2, s[32:35], s91 offen offset:0 sc1
  buffer_load_dwordx4 a[100:103], v2, s[32:35], s91 offen offset:1024 sc1
  v_exp_f32 v100, v100
  v_exp_f32 v101, v101
  v_exp_f32 v102, v102
  v_exp_f32 v103, v103
  v_cvt_pk_bf16_f32 v132, v100, v101
  v_cvt_pk_bf16_f32 v133, v102, v103
  v_mfma_f32_32x32x16_bf16 v[116:131], a[228:231], v[96:99], v[116:131]
  s_waitcnt vmcnt(20)
  v_exp_f32 v104, v104
  v_exp_f32 v105, v105
  v_exp_f32 v106, v106
  v_exp_f32 v107, v107
  v_cvt_pk_bf16_f32 v134, v104, v105
  v_cvt_pk_bf16_f32 v135, v106, v107
  v_mfma_f32_32x32x16_bf16 v[52:67], a[232:235], v[140:143], v[52:67]
  v_exp_f32 v108, v108
  v_exp_f32 v109, v109
  v_exp_f32 v110, v110
  v_exp_f32 v111, v111
  v_cvt_pk_bf16_f32 v136, v108, v109
  v_cvt_pk_bf16_f32 v137, v110, v111
  v_mfma_f32_32x32x16_bf16 v[52:67], a[236:239], v[144:147], v[52:67]
  v_exp_f32 v112, v112
  v_exp_f32 v113, v113
  v_exp_f32 v114, v114
  v_exp_f32 v115, v115
  v_cvt_pk_bf16_f32 v138, v112, v113
  v_cvt_pk_bf16_f32 v139, v114, v115
  v_mfma_f32_32x32x16_bf16 v[100:115], a[224:227], v[68:71], 0
  buffer_load_dwordx4 a[104:107], v2, s[32:35], s91 offen offset:2048 sc1
  buffer_load_dwordx4 a[108:111], v2, s[32:35], s91 offen offset:3072 sc1
  v_exp_f32 v116, v116
  v_exp_f32 v117, v117
  v_exp_f32 v118, v118
  v_exp_f32 v119, v119
  v_cvt_pk_bf16_f32 v140, v116, v117
  v_cvt_pk_bf16_f32 v141, v118, v119
  v_mfma_f32_32x32x16_bf16 v[100:115], a[228:231], v[72:75], v[100:115]
  v_exp_f32 v120, v120
  v_exp_f32 v121, v121
  v_exp_f32 v122, v122
  v_exp_f32 v123, v123
  v_cvt_pk_bf16_f32 v142, v120, v121
  v_cvt_pk_bf16_f32 v143, v122, v123
  v_mfma_f32_32x32x16_bf16 v[148:163], a[232:235], v[132:135], v[148:163]
  v_exp_f32 v124, v124
  v_exp_f32 v125, v125
  v_exp_f32 v126, v126
  v_exp_f32 v127, v127
  v_cvt_pk_bf16_f32 v144, v124, v125
  v_cvt_pk_bf16_f32 v145, v126, v127
  v_mfma_f32_32x32x16_bf16 v[148:163], a[236:239], v[136:139], v[148:163]
  s_waitcnt vmcnt(18)
  s_add_u32 s91, s91, 4096
  v_exp_f32 v128, v128
  v_exp_f32 v129, v129
  v_exp_f32 v130, v130
  v_exp_f32 v131, v131
  v_cvt_pk_bf16_f32 v146, v128, v129
  v_cvt_pk_bf16_f32 v147, v130, v131
  v_mfma_f32_32x32x16_bf16 v[116:131], a[240:243], v[76:79], 0
  buffer_load_dwordx4 a[112:115], v2, s[32:35], s91 offen offset:0 sc1
  buffer_load_dwordx4 a[116:119], v2, s[32:35], s91 offen offset:1024 sc1
  v_exp_f32 v100, v100
  v_exp_f32 v101, v101
  v_exp_f32 v102, v102
  v_exp_f32 v103, v103
  v_cvt_pk_bf16_f32 v132, v100, v101
  v_cvt_pk_bf16_f32 v133, v102, v103
  v_mfma_f32_32x32x16_bf16 v[116:131], a[244:247], v[80:83], v[116:131]
  v_exp_f32 v104, v104
  v_exp_f32 v105, v105
  v_exp_f32 v106, v106
  v_exp_f32 v107, v107
  v_cvt_pk_bf16_f32 v134, v104, v105
  v_cvt_pk_bf16_f32 v135, v106, v107
  v_mfma_f32_32x32x16_bf16 v[164:179], a[232:235], v[140:143], v[164:179]
  v_exp_f32 v108, v108
  v_exp_f32 v109, v109
  v_exp_f32 v110, v110
  v_exp_f32 v111, v111
  v_cvt_pk_bf16_f32 v136, v108, v109
  v_cvt_pk_bf16_f32 v137, v110, v111
  v_mfma_f32_32x32x16_bf16 v[164:179], a[236:239], v[144:147], v[164:179]
  v_exp_f32 v112, v112
  v_exp_f32 v113, v113
  v_exp_f32 v114, v114
  v_exp_f32 v115, v115
  v_cvt_pk_bf16_f32 v138, v112, v113
  v_cvt_pk_bf16_f32 v139, v114, v115
  v_mfma_f32_32x32x16_bf16 v[100:115], a[240:243], v[84:87], 0
  buffer_load_dwordx4 a[120:123], v2, s[32:35], s91 offen offset:2048 sc1
  buffer_load_dwordx4 a[124:127], v2, s[32:35], s91 offen offset:3072 sc1
  v_exp_f32 v116, v116
  v_exp_f32 v117, v117
  v_exp_f32 v118, v118
  v_exp_f32 v119, v119
  v_cvt_pk_bf16_f32 v140, v116, v117
  v_cvt_pk_bf16_f32 v141, v118, v119
  v_mfma_f32_32x32x16_bf16 v[100:115], a[244:247], v[88:91], v[100:115]
  v_exp_f32 v120, v120
  v_exp_f32 v121, v121
  v_exp_f32 v122, v122
  v_exp_f32 v123, v123
  v_cvt_pk_bf16_f32 v142, v120, v121
  v_cvt_pk_bf16_f32 v143, v122, v123
  v_mfma_f32_32x32x16_bf16 v[36:51], a[232:235], v[132:135], v[36:51]
  v_exp_f32 v124, v124
  v_exp_f32 v125, v125
  v_exp_f32 v126, v126
  v_exp_f32 v127, v127
  v_cvt_pk_bf16_f32 v144, v124, v125
  v_cvt_pk_bf16_f32 v145, v126, v127
  v_mfma_f32_32x32x16_bf16 v[36:51], a[236:239], v[136:139], v[36:51]
  v_exp_f32 v128, v128
  v_exp_f32 v129, v129
  v_exp_f32 v130, v130
  v_exp_f32 v131, v131
  v_cvt_pk_bf16_f32 v146, v128, v129
  v_cvt_pk_bf16_f32 v147, v130, v131
  v_mfma_f32_32x32x16_bf16 v[116:131], a[240:243], v[92:95], 0
  v_exp_f32 v100, v100
  v_exp_f32 v101, v101
  v_exp_f32 v102, v102
  v_exp_f32 v103, v103
  v_cvt_pk_bf16_f32 v132, v100, v101
  v_cvt_pk_bf16_f32 v133, v102, v103
  v_mfma_f32_32x32x16_bf16 v[116:131], a[244:247], v[96:99], v[116:131]
  s_waitcnt vmcnt(18)
  v_exp_f32 v104, v104
  v_exp_f32 v105, v105
  v_exp_f32 v106, v106
  v_exp_f32 v107, v107
  v_cvt_pk_bf16_f32 v134, v104, v105
  v_cvt_pk_bf16_f32 v135, v106, v107
  v_mfma_f32_32x32x16_bf16 v[52:67], a[248:251], v[140:143], v[52:67]
  v_exp_f32 v108, v108
  v_exp_f32 v109, v109
  v_exp_f32 v110, v110
  v_exp_f32 v111, v111
  v_cvt_pk_bf16_f32 v136, v108, v109
  v_cvt_pk_bf16_f32 v137, v110, v111
  v_mfma_f32_32x32x16_bf16 v[52:67], a[252:255], v[144:147], v[52:67]
  v_exp_f32 v112, v112
  v_exp_f32 v113, v113
  v_exp_f32 v114, v114
  v_exp_f32 v115, v115
  v_cvt_pk_bf16_f32 v138, v112, v113
  v_cvt_pk_bf16_f32 v139, v114, v115
  v_mfma_f32_32x32x16_bf16 v[100:115], a[240:243], v[68:71], 0
  v_exp_f32 v116, v116
  v_exp_f32 v117, v117
  v_exp_f32 v118, v118
  v_exp_f32 v119, v119
  v_cvt_pk_bf16_f32 v140, v116, v117
  v_cvt_pk_bf16_f32 v141, v118, v119
  v_mfma_f32_32x32x16_bf16 v[100:115], a[244:247], v[72:75], v[100:115]
  v_exp_f32 v120, v120
  v_exp_f32 v121, v121
  v_exp_f32 v122, v122
  v_exp_f32 v123, v123
  v_cvt_pk_bf16_f32 v142, v120, v121
  v_cvt_pk_bf16_f32 v143, v122, v123
  v_mfma_f32_32x32x16_bf16 v[148:163], a[248:251], v[132:135], v[148:163]
  v_exp_f32 v124, v124
  v_exp_f32 v125, v125
  v_exp_f32 v126, v126
  v_exp_f32 v127, v127
  v_cvt_pk_bf16_f32 v144, v124, v125
  v_cvt_pk_bf16_f32 v145, v126, v127
  v_mfma_f32_32x32x16_bf16 v[148:163], a[252:255], v[136:139], v[148:163]
  v_exp_f32 v128, v128
  v_exp_f32 v129, v129
  v_exp_f32 v130, v130
  v_exp_f32 v131, v131
  v_cvt_pk_bf16_f32 v146, v128, v129
  v_cvt_pk_bf16_f32 v147, v130, v131
  v_exp_f32 v100, v100
  v_exp_f32 v101, v101
  v_exp_f32 v102, v102
  v_exp_f32 v103, v103
  v_cvt_pk_bf16_f32 v132, v100, v101
  v_cvt_pk_bf16_f32 v133, v102, v103
  ds_write_b128 v189, v[52:55] offset:0
  v_exp_f32 v104, v104
  v_exp_f32 v105, v105
  v_exp_f32 v106, v106
  v_exp_f32 v107, v107
  v_cvt_pk_bf16_f32 v134, v104, v105
  v_cvt_pk_bf16_f32 v135, v106, v107
  ds_write_b128 v189, v[56:59] offset:1024
  v_mfma_f32_32x32x16_bf16 v[164:179], a[248:251], v[140:143], v[164:179]
  v_exp_f32 v108, v108
  v_exp_f32 v109, v109
  v_exp_f32 v110, v110
  v_exp_f32 v111, v111
  v_cvt_pk_bf16_f32 v136, v108, v109
  v_cvt_pk_bf16_f32 v137, v110, v111
  ds_write_b128 v189, v[60:63] offset:2048
  v_mfma_f32_32x32x16_bf16 v[164:179], a[252:255], v[144:147], v[164:179]
  v_exp_f32 v112, v112
  v_exp_f32 v113, v113
  v_exp_f32 v114, v114
  v_exp_f32 v115, v115
  v_cvt_pk_bf16_f32 v138, v112, v113
  v_cvt_pk_bf16_f32 v139, v114, v115
  ds_write_b128 v189, v[64:67] offset:3072
  s_nop 1
  ds_write_b128 v190, v[148:151] offset:0
  ds_write_b128 v190, v[152:155] offset:1024
  ds_write_b128 v190, v[156:159] offset:2048
  ds_write_b128 v190, v[160:163] offset:3072
  v_mfma_f32_32x32x16_bf16 v[36:51], a[248:251], v[132:135], v[36:51]
  v_mfma_f32_32x32x16_bf16 v[36:51], a[252:255], v[136:139], v[36:51]
  s_nop 7
  ds_write_b128 v191, v[164:167] offset:0
  ds_write_b128 v191, v[168:171] offset:1024
  ds_write_b128 v191, v[172:175] offset:2048
  ds_write_b128 v191, v[176:179] offset:3072
  s_waitcnt lgkmcnt(0)
  s_barrier
  ds_read_b128 v[100:103], v17 offset:0
  ds_read_b128 v[104:107], v17 offset:1024
  ds_read_b128 v[108:111], v17 offset:2048
  ds_read_b128 v[112:115], v17 offset:3072
  ds_read_b128 v[116:119], v17 offset:4096
  ds_read_b128 v[120:123], v17 offset:5120
  ds_read_b128 v[124:127], v17 offset:6144
  ds_read_b128 v[128:131], v17 offset:7168
  ds_read_b128 v[132:135], v17 offset:8192
  ds_read_b128 v[136:139], v17 offset:9216
  ds_read_b128 v[140:143], v17 offset:10240
  ds_read_b128 v[144:147], v17 offset:11264
  s_waitcnt lgkmcnt(8)
  v_pk_add_f32 v[36:37], v[36:37], v[100:101]
  v_pk_add_f32 v[38:39], v[38:39], v[102:103]
  v_pk_add_f32 v[40:41], v[40:41], v[104:105]
  v_pk_add_f32 v[42:43], v[42:43], v[106:107]
  v_pk_add_f32 v[44:45], v[44:45], v[108:109]
  v_pk_add_f32 v[46:47], v[46:47], v[110:111]
  v_pk_add_f32 v[48:49], v[48:49], v[112:113]
  v_pk_add_f32 v[50:51], v[50:51], v[114:115]
  s_waitcnt lgkmcnt(4)
  v_pk_add_f32 v[36:37], v[36:37], v[116:117]
  v_pk_add_f32 v[38:39], v[38:39], v[118:119]
  v_pk_add_f32 v[40:41], v[40:41], v[120:121]
  v_pk_add_f32 v[42:43], v[42:43], v[122:123]
  v_pk_add_f32 v[44:45], v[44:45], v[124:125]
  v_pk_add_f32 v[46:47], v[46:47], v[126:127]
  v_pk_add_f32 v[48:49], v[48:49], v[128:129]
  v_pk_add_f32 v[50:51], v[50:51], v[130:131]
  s_waitcnt lgkmcnt(0)
  v_pk_add_f32 v[36:37], v[36:37], v[132:133]
  v_pk_add_f32 v[38:39], v[38:39], v[134:135]
  v_pk_add_f32 v[40:41], v[40:41], v[136:137]
  v_pk_add_f32 v[42:43], v[42:43], v[138:139]
  v_pk_add_f32 v[44:45], v[44:45], v[140:141]
  v_pk_add_f32 v[46:47], v[46:47], v[142:143]
  v_pk_add_f32 v[48:49], v[48:49], v[144:145]
  v_pk_add_f32 v[50:51], v[50:51], v[146:147]
L_finB:
  v_mov_b32 v3, v48
  v_mov_b32 v4, v48
  v_pk_add_f32 v[28:29], v[36:37], v[38:39]
  v_pk_add_f32 v[30:31], v[40:41], v[42:43]
  v_permlane32_swap_b32 v3, v4
  v_pk_add_f32 v[28:29], v[28:29], v[44:45]
  v_pk_add_f32 v[30:31], v[30:31], v[46:47]
  v_pk_add_f32 v[28:29], v[28:29], v[48:49]
  v_pk_add_f32 v[30:31], v[30:31], v[50:51]
  s_mov_b32 s13, 0x207
  v_pk_add_f32 v[28:29], v[28:29], v[30:31]
  v_cmp_nlt_f32 vcc, 0xd800000, v4
  v_add_f32 v28, v28, v29
  s_mov_b32 s11, 0x5f800000
  v_cmp_ngt_f32_e64 s[76:77], s11, v4
  v_cmp_class_f32_e64 s[78:79], v28, s13
  v_rcp_f32 v4, v4
  s_or_b64 vcc, vcc, s[76:77]
  s_or_b64 vcc, vcc, s[78:79]
  s_bitcmp1_b32 s4, 1
  s_cselect_b64 vcc, 0, vcc
  s_cbranch_vccnz L_slowB
  v_mul_f32 v36, v36, v4
  v_mul_f32 v37, v37, v4
  v_mul_f32 v38, v38, v4
  v_mul_f32 v39, v39, v4
  v_mul_f32 v40, v40, v4
  v_mul_f32 v41, v41, v4
  v_mul_f32 v42, v42, v4
  v_mul_f32 v43, v43, v4
  v_mul_f32 v44, v44, v4
  v_mul_f32 v45, v45, v4
  v_mul_f32 v46, v46, v4
  v_mul_f32 v47, v47, v4
  v_mul_f32 v48, v48, v4
  v_mul_f32 v49, v49, v4
  v_mul_f32 v50, v50, v4
  v_mul_f32 v51, v51, v4
  v_cvt_pk_bf16_f32 v28, v36, v37
  v_cvt_pk_bf16_f32 v29, v38, v39
  v_cvt_pk_bf16_f32 v30, v40, v41
  v_cvt_pk_bf16_f32 v31, v42, v43
  v_cvt_pk_bf16_f32 v32, v44, v45
  v_cvt_pk_bf16_f32 v33, v46, v47
  v_cvt_pk_bf16_f32 v34, v48, v49
  v_cvt_pk_bf16_f32 v35, v50, v51
  s_mov_b32 exec_lo, 0
  v_mov_b32 v34, 0
  v_mov_b32 v35, 0
  s_mov_b32 exec_lo, -1
  s_lshl_b32 s52, s89, 4
  s_add_u32 s52, s52, s67
  s_lshl_b32 s72, s52, 11
  s_add_u32 s72, s72, 8388608
  buffer_store_dwordx4 v[28:31], v2, s[32:35], s72 offen sc1
  buffer_store_dwordx4 v[32:35], v2, s[32:35], s72 offen offset:1024 sc1
  s_cmp_lt_u32 s2, 224
  s_cbranch_scc1 L_p3_12
  s_waitcnt vmcnt(0)
  v_mov_b32 v3, 0
  v_mov_b32 v4, s66
  s_mov_b64 exec, 1
  buffer_store_dword v4, v3, s[32:35], s85 offen sc1
  s_mov_b64 exec, -1
  s_endpgm
L_p3_12:
  v_mov_b32 v16, v12
  v_add_u32 v17, 57344, v12
  v_lshrrev_b32 v3, 5, v1
  v_lshlrev_b32 v3, 9, v3
  v_sub_u32 v18, v16, v3
  v_sub_u32 v19, v17, v3
  v_and_b32 v3, 31, v1
  v_mul_u32_u24 v3, 1792, v3
  v_lshrrev_b32 v4, 5, v1
  v_lshl_add_u32 v190, v4, 4, v3
  s_barrier
  ds_read_b64_tr_b16 v[36:37], v17 offset:0
  ds_read_b64_tr_b16 v[38:39], v17 offset:1024
  ds_read_b64_tr_b16 v[40:41], v17 offset:2048
  ds_read_b64_tr_b16 v[42:43], v17 offset:3072
  ds_read_b64_tr_b16 v[44:45], v17 offset:3584
  ds_read_b64_tr_b16 v[46:47], v17 offset:4608
  s_waitcnt lgkmcnt(4)
  v_mfma_f32_32x32x16_bf16 v[68:83], v[36:39], a[0:3], 0
  ds_read_b64_tr_b16 v[48:49], v17 offset:5632
  ds_read_b64_tr_b16 v[50:51], v17 offset:6656
  s_waitcnt lgkmcnt(4)
  v_mfma_f32_32x32x16_bf16 v[68:83], v[40:43], a[4:7], v[68:83]
  ds_read_b64_tr_b16 v[36:37], v17 offset:7168
  ds_read_b64_tr_b16 v[38:39], v17 offset:8192
  s_waitcnt lgkmcnt(4)
  v_mfma_f32_32x32x16_bf16 v[68:83], v[44:47], a[8:11], v[68:83]
  ds_read_b64_tr_b16 v[40:41], v17 offset:9216
  ds_read_b64_tr_b16 v[42:43], v17 offset:10240
  s_waitcnt lgkmcnt(4)
  v_mfma_f32_32x32x16_bf16 v[68:83], v[48:51], a[12:15], v[68:83]
  ds_read_b64_tr_b16 v[44:45], v17 offset:10752
  ds_read_b64_tr_b16 v[46:47], v17 offset:11776
  s_waitcnt lgkmcnt(4)
  v_mfma_f32_32x32x16_bf16 v[68:83], v[36:39], a[16:19], v[68:83]
  ds_read_b64_tr_b16 v[48:49], v17 offset:12800
  ds_read_b64_tr_b16 v[50:51], v17 offset:13824
  s_waitcnt lgkmcnt(4)
  v_mfma_f32_32x32x16_bf16 v[68:83], v[40:43], a[20:23], v[68:83]
  ds_read_b64_tr_b16 v[36:37], v17 offset:14336
  ds_read_b64_tr_b16 v[38:39], v17 offset:15360
  s_waitcnt lgkmcnt(4)
  v_mfma_f32_32x32x16_bf16 v[68:83], v[44:47], a[24:27], v[68:83]
  ds_read_b64_tr_b16 v[40:41], v17 offset:16384
  ds_read_b64_tr_b16 v[42:43], v17 offset:17408
  s_waitcnt lgkmcnt(4)
  v_mfma_f32_32x32x16_bf16 v[68:83], v[48:51], a[28:31], v[68:83]
  ds_read_b64_tr_b16 v[44:45], v17 offset:17920
  ds_read_b64_tr_b16 v[46:47], v17 offset:18944
  s_waitcnt lgkmcnt(4)
  v_mfma_f32_32x32x16_bf16 v[68:83], v[36:39], a[32:35], v[68:83]
  ds_read_b64_tr_b16 v[48:49], v17 offset:19968
  ds_read_b64_tr_b16 v[50:51], v17 offset:20992
  s_waitcnt lgkmcnt(4)
  v_mfma_f32_32x32x16_bf16 v[68:83], v[40:43], a[36:39], v[68:83]
  ds_read_b64_tr_b16 v[36:37], v17 offset:21504
  ds_read_b64_tr_b16 v[38:39], v17 offset:22528
  s_waitcnt lgkmcnt(4)
  v_mfma_f32_32x32x16_bf16 v[68:83], v[44:47], a[40:43], v[68:83]
  ds_read_b64_tr_b16 v[40:41], v17 offset:23552
  ds_read_b64_tr_b16 v[42:43], v17 offset:24576
  s_waitcnt lgkmcnt(4)
  v_mfma_f32_32x32x16_bf16 v[68:83], v[48:51], a[44:47], v[68:83]
  ds_read_b64_tr_b16 v[44:45], v17 offset:25088
  ds_read_b64_tr_b16 v[46:47], v17 offset:26112
  s_waitcnt lgkmcnt(4)
  v_mfma_f32_32x32x16_bf16 v[68:83], v[36:39], a[48:51], v[68:83]
  ds_read_b64_tr_b16 v[48:49], v17 offset:27136
  ds_read_b64_tr_b16 v[50:51], v17 offset:28160
  s_waitcnt lgkmcnt(4)
  v_mfma_f32_32x32x16_bf16 v[68:83], v[40:43], a[52:55], v[68:83]
  ds_read_b64_tr_b16 v[36:37], v17 offset:28672
  ds_read_b64_tr_b16 v[38:39], v17 offset:29696
  s_waitcnt vmcnt(19) lgkmcnt(4)
  v_mfma_f32_32x32x16_bf16 v[68:83], v[44:47], a[56:59], v[68:83]
  ds_read_b64_tr_b16 v[40:41], v17 offset:30720
  ds_read_b64_tr_b16 v[42:43], v17 offset:31744
  s_waitcnt vmcnt(18) lgkmcnt(4)
  v_mfma_f32_32x32x16_bf16 v[68:83], v[48:51], a[60:63], v[68:83]
  ds_read_b64_tr_b16 v[44:45], v17 offset:32256
  ds_read_b64_tr_b16 v[46:47], v17 offset:33280
  s_waitcnt vmcnt(17) lgkmcnt(4)
  v_mfma_f32_32x32x16_bf16 v[68:83], v[36:39], a[64:67], v[68:83]
  ds_read_b64_tr_b16 v[48:49], v17 offset:34304
  ds_read_b64_tr_b16 v[50:51], v17 offset:35328
  s_waitcnt vmcnt(16) lgkmcnt(4)
  v_mfma_f32_32x32x16_bf16 v[68:83], v[40:43], a[68:71], v[68:83]
  ds_read_b64_tr_b16 v[36:37], v17 offset:35840
  ds_read_b64_tr_b16 v[38:39], v17 offset:36864
  s_waitcnt vmcnt(15) lgkmcnt(4)
  v_mfma_f32_32x32x16_bf16 v[68:83], v[44:47], a[72:75], v[68:83]
  ds_read_b64_tr_b16 v[40:41], v17 offset:37888
  ds_read_b64_tr_b16 v[42:43], v17 offset:38912
  s_waitcnt vmcnt(14) lgkmcnt(4)
  v_mfma_f32_32x32x16_bf16 v[68:83], v[48:51], a[76:79], v[68:83]
  ds_read_b64_tr_b16 v[44:45], v17 offset:39424
  ds_read_b64_tr_b16 v[46:47], v17 offset:40448
  s_waitcnt vmcnt(13) lgkmcnt(4)
  v_mfma_f32_32x32x16_bf16 v[68:83], v[36:39], a[80:83], v[68:83]
  ds_read_b64_tr_b16 v[48:49], v17 offset:41472
  ds_read_b64_tr_b16 v[50:51], v17 offset:42496
  s_waitcnt vmcnt(12) lgkmcnt(4)
  v_mfma_f32_32x32x16_bf16 v[68:83], v[40:43], a[84:87], v[68:83]
  ds_read_b64_tr_b16 v[36:37], v17 offset:43008
  ds_read_b64_tr_b16 v[38:39], v17 offset:44032
  s_waitcnt vmcnt(11) lgkmcnt(4)
  v_mfma_f32_32x32x16_bf16 v[68:83], v[44:47], a[88:91], v[68:83]
  ds_read_b64_tr_b16 v[40:41], v17 offset:45056
  ds_read_b64_tr_b16 v[42:43], v17 offset:46080
  s_waitcnt vmcnt(10) lgkmcnt(4)
  v_mfma_f32_32x32x16_bf16 v[68:83], v[48:51], a[92:95], v[68:83]
  ds_read_b64_tr_b16 v[44:45], v17 offset:46592
  ds_read_b64_tr_b16 v[46:47], v17 offset:47616
  s_waitcnt vmcnt(9) lgkmcnt(4)
  v_mfma_f32_32x32x16_bf16 v[68:83], v[36:39], a[96:99], v[68:83]
  ds_read_b64_tr_b16 v[48:49], v17 offset:48640
  ds_read_b64_tr_b16 v[50:51], v17 offset:49664
  s_waitcnt vmcnt(8) lgkmcnt(4)
  v_mfma_f32_32x32x16_bf16 v[68:83], v[40:43], a[100:103], v[68:83]
  ds_read_b64_tr_b16 v[36:37], v17 offset:50176
  ds_read_b64_tr_b16 v[38:39], v17 offset:51200
  s_waitcnt vmcnt(7) lgkmcnt(4)
  v_mfma_f32_32x32x16_bf16 v[68:83], v[44:47], a[104:107], v[68:83]
  ds_read_b64_tr_b16 v[40:41], v17 offset:52224
  ds_read_b64_tr_b16 v[42:43], v17 offset:53248
  s_waitcnt vmcnt(6) lgkmcnt(4)
  v_mfma_f32_32x32x16_bf16 v[68:83], v[48:51], a[108:111], v[68:83]
  ds_read_b64_tr_b16 v[44:45], v17 offset:53760
  ds_read_b64_tr_b16 v[46:47], v17 offset:54784
  s_waitcnt vmcnt(5) lgkmcnt(4)
  v_mfma_f32_32x32x16_bf16 v[68:83], v[36:39], a[112:115], v[68:83]
  ds_read_b64_tr_b16 v[48:49], v17 offset:55808
  ds_read_b64_tr_b16 v[50:51], v19 offset:56832
  s_waitcnt vmcnt(4) lgkmcnt(4)
  v_mfma_f32_32x32x16_bf16 v[68:83], v[40:43], a[116:119], v[68:83]
  s_waitcnt vmcnt(3) lgkmcnt(2)
  v_mfma_f32_32x32x16_bf16 v[68:83], v[44:47], a[120:123], v[68:83]
  s_waitcnt vmcnt(2) lgkmcnt(0)
  v_mfma_f32_32x32x16_bf16 v[68:83], v[48:51], a[124:127], v[68:83]
  s_waitcnt vmcnt(0)
  v_mov_b32 v3, 0
  v_mov_b32 v4, s66
  s_mov_b64 exec, 1
  buffer_store_dword v4, v3, s[32:35], s85 offen sc1
  s_mov_b64 exec, -1
  s_mov_b64 exec, 0xff
  buffer_load_dwordx4 v[180:183], v8, s[32:35], 0 offen sc1
  s_mov_b64 exec, -1
  s_nop 11
  v_cvt_pk_bf16_f32 v84, v68, v69
  v_cvt_pk_bf16_f32 v85, v70, v71
  v_cvt_pk_bf16_f32 v86, v72, v73
  v_cvt_pk_bf16_f32 v87, v74, v75
  v_cvt_pk_bf16_f32 v88, v76, v77
  v_cvt_pk_bf16_f32 v89, v78, v79
  v_cvt_pk_bf16_f32 v90, v80, v81
  v_cvt_pk_bf16_f32 v91, v82, v83
  s_lshl_b32 s53, s74, 1
  s_and_b32 s52, s48, 1
  s_add_u32 s53, s53, s52
  v_permlane32_swap_b32 v84, v86
  v_permlane32_swap_b32 v85, v87
  v_permlane32_swap_b32 v88, v90
  v_permlane32_swap_b32 v89, v91
  s_mul_i32 s72, s68, 57344
  s_lshl_b32 s52, s53, 6
  s_add_u32 s72, s72, s52
  buffer_store_dwordx4 v[84:87], v190, s[36:39], s72 offen nt
  buffer_store_dwordx4 v[88:91], v190, s[36:39], s72 offen offset:32 nt
  s_barrier
  s_waitcnt vmcnt(2)
  s_mov_b64 exec, 0xff
  v_xor_b32 v188, s66, v180
  v_xor_b32 v181, s66, v181
  v_xor_b32 v182, s66, v182
  v_xor_b32 v183, s66, v183
  v_or3_b32 v188, v188, v181, v182
  v_or_b32 v188, v188, v183
  v_cmp_ne_u32 vcc, 0, v188
  s_mov_b32 s73, 0
  s_cbranch_vccz L_poBd_14
  buffer_load_dwordx4 v[180:183], v8, s[32:35], 0 offen sc1
L_poB_13:
  buffer_load_dwordx4 v[184:187], v8, s[32:35], 0 offen sc1
  s_waitcnt vmcnt(1)
  v_xor_b32 v188, s66, v180
  v_xor_b32 v181, s66, v181
  v_xor_b32 v182, s66, v182
  v_xor_b32 v183, s66, v183
  v_or3_b32 v188, v188, v181, v182
  v_or_b32 v188, v188, v183
  v_cmp_ne_u32 vcc, 0, v188
  s_add_u32 s73, s73, 1
  s_cbranch_vccz L_poBd_14
  buffer_load_dwordx4 v[180:183], v8, s[32:35], 0 offen sc1
  s_waitcnt vmcnt(1)
  v_xor_b32 v188, s66, v184
  v_xor_b32 v185, s66, v185
  v_xor_b32 v186, s66, v186
  v_xor_b32 v187, s66, v187
  v_or3_b32 v188, v188, v185, v186
  v_or_b32 v188, v188, v187
  v_cmp_ne_u32 vcc, 0, v188
  s_cmp_gt_u32 s73, 262144
  s_cbranch_scc1 L_poBd_14
  s_cbranch_vccnz L_poB_13
L_poBd_14:
  s_mov_b64 exec, -1
  s_lshl_b32 s72, s75, 16
  s_add_u32 s72, s72, 8388608
  s_lshr_b32 s52, s48, 1
  s_lshl_b32 s52, s52, 15
  s_and_b32 s53, s48, 1
  s_lshl_b32 s53, s53, 13
  s_add_u32 s52, s52, s53
  s_add_u32 s72, s72, s52
  s_add_u32 s53, s52, 57344
  s_add_u32 m0, s53, 0
  s_add_u32 s52, s72, 0
  buffer_load_dwordx4 v2, s[32:35], s52 offen offset:0 sc1 lds
  buffer_load_dwordx4 v2, s[32:35], s52 offen offset:1024 sc1 lds
  buffer_load_dwordx4 v2, s[32:35], s52 offen offset:2048 sc1 lds
  buffer_load_dwordx4 v2, s[32:35], s52 offen offset:3072 sc1 lds
  s_add_u32 m0, s53, 4096
  s_add_u32 s52, s72, 4096
  buffer_load_dwordx4 v2, s[32:35], s52 offen offset:0 sc1 lds
  buffer_load_dwordx4 v2, s[32:35], s52 offen offset:1024 sc1 lds
  buffer_load_dwordx4 v2, s[32:35], s52 offen offset:2048 sc1 lds
  buffer_load_dwordx4 v2, s[32:35], s52 offen offset:3072 sc1 lds
  s_add_u32 m0, s53, 16384
  s_add_u32 s52, s72, 16384
  buffer_load_dwordx4 v2, s[32:35], s52 offen offset:0 sc1 lds
  buffer_load_dwordx4 v2, s[32:35], s52 offen offset:1024 sc1 lds
  buffer_load_dwordx4 v2, s[32:35], s52 offen offset:2048 sc1 lds
  buffer_load_dwordx4 v2, s[32:35], s52 offen offset:3072 sc1 lds
  s_add_u32 m0, s53, 20480
  s_add_u32 s52, s72, 20480
  buffer_load_dwordx4 v2, s[32:35], s52 offen offset:0 sc1 lds
  buffer_load_dwordx4 v2, s[32:35], s52 offen offset:1024 sc1 lds
  buffer_load_dwordx4 v2, s[32:35], s52 offen offset:2048 sc1 lds
  buffer_load_dwordx4 v2, s[32:35], s52 offen offset:3072 sc1 lds
  s_lshr_b32 s52, s48, 1
  s_lshl_b32 s52, s52, 15
  s_add_u32 s52, s52, 57344
  v_add_u32 v189, s52, v2
  ds_read_b64_tr_b16 v[36:37], v16 offset:0
  ds_read_b64_tr_b16 v[38:39], v16 offset:1024
  ds_read_b64_tr_b16 v[40:41], v16 offset:2048
  ds_read_b64_tr_b16 v[42:43], v16 offset:3072
  ds_read_b64_tr_b16 v[44:45], v16 offset:3584
  ds_read_b64_tr_b16 v[46:47], v16 offset:4608
  s_waitcnt vmcnt(8)
  s_barrier
  ds_read_b128 v[52:55], v189 offset:0
  ds_read_b128 v[56:59], v189 offset:1024
  ds_read_b128 v[60:63], v189 offset:2048
  s_waitcnt lgkmcnt(2)
  v_mfma_f32_32x32x16_bf16 v[68:83], v[36:39], v[52:55], 0
  ds_read_b64_tr_b16 v[48:49], v16 offset:5632
  ds_read_b64_tr_b16 v[50:51], v16 offset:6656
  ds_read_b128 v[64:67], v189 offset:3072
  s_waitcnt lgkmcnt(4)
  v_mfma_f32_32x32x16_bf16 v[68:83], v[40:43], v[56:59], v[68:83]
  ds_read_b64_tr_b16 v[36:37], v16 offset:7168
  ds_read_b64_tr_b16 v[38:39], v16 offset:8192
  ds_read_b128 v[52:55], v189 offset:4096
  s_waitcnt lgkmcnt(6)
  v_mfma_f32_32x32x16_bf16 v[68:83], v[44:47], v[60:63], v[68:83]
  ds_read_b64_tr_b16 v[40:41], v16 offset:9216
  ds_read_b64_tr_b16 v[42:43], v16 offset:10240
  ds_read_b128 v[56:59], v189 offset:5120
  s_waitcnt lgkmcnt(6)
  v_mfma_f32_32x32x16_bf16 v[68:83], v[48:51], v[64:67], v[68:83]
  ds_read_b64_tr_b16 v[44:45], v16 offset:10752
  ds_read_b64_tr_b16 v[46:47], v16 offset:11776
  ds_read_b128 v[60:63], v189 offset:6144
  s_waitcnt lgkmcnt(6)
  v_mfma_f32_32x32x16_bf16 v[68:83], v[36:39], v[52:55], v[68:83]
  ds_read_b64_tr_b16 v[48:49], v16 offset:12800
  ds_read_b64_tr_b16 v[50:51], v16 offset:13824
  ds_read_b128 v[64:67], v189 offset:7168
  s_waitcnt lgkmcnt(6)
  v_mfma_f32_32x32x16_bf16 v[68:83], v[40:43], v[56:59], v[68:83]
  ds_read_b64_tr_b16 v[36:37], v16 offset:14336
  ds_read_b64_tr_b16 v[38:39], v16 offset:15360
  ds_read_b128 v[52:55], v189 offset:8192
  s_waitcnt lgkmcnt(6)
  v_mfma_f32_32x32x16_bf16 v[68:83], v[44:47], v[60:63], v[68:83]
  ds_read_b64_tr_b16 v[40:41], v16 offset:16384
  ds_read_b64_tr_b16 v[42:43], v16 offset:17408
  ds_read_b128 v[56:59], v189 offset:9216
  s_waitcnt lgkmcnt(6)
  v_mfma_f32_32x32x16_bf16 v[68:83], v[48:51], v[64:67], v[68:83]
  ds_read_b64_tr_b16 v[44:45], v16 offset:17920
  ds_read_b64_tr_b16 v[46:47], v16 offset:18944
  ds_read_b128 v[60:63], v189 offset:10240
  s_waitcnt lgkmcnt(6)
  v_mfma_f32_32x32x16_bf16 v[68:83], v[36:39], v[52:55], v[68:83]
  ds_read_b64_tr_b16 v[48:49], v16 offset:19968
  ds_read_b64_tr_b16 v[50:51], v16 offset:20992
  ds_read_b128 v[64:67], v189 offset:11264
  s_waitcnt lgkmcnt(6)
  v_mfma_f32_32x32x16_bf16 v[68:83], v[40:43], v[56:59], v[68:83]
  ds_read_b64_tr_b16 v[36:37], v16 offset:21504
  ds_read_b64_tr_b16 v[38:39], v16 offset:22528
  ds_read_b128 v[52:55], v189 offset:12288
  s_waitcnt lgkmcnt(6)
  v_mfma_f32_32x32x16_bf16 v[68:83], v[44:47], v[60:63], v[68:83]
  ds_read_b64_tr_b16 v[40:41], v16 offset:23552
  ds_read_b64_tr_b16 v[42:43], v16 offset:24576
  ds_read_b128 v[56:59], v189 offset:13312
  s_waitcnt lgkmcnt(6)
  v_mfma_f32_32x32x16_bf16 v[68:83], v[48:51], v[64:67], v[68:83]
  ds_read_b64_tr_b16 v[44:45], v16 offset:25088
  ds_read_b64_tr_b16 v[46:47], v16 offset:26112
  ds_read_b128 v[60:63], v189 offset:14336
  s_waitcnt lgkmcnt(6)
  v_mfma_f32_32x32x16_bf16 v[68:83], v[36:39], v[52:55], v[68:83]
  ds_read_b64_tr_b16 v[48:49], v16 offset:27136
  ds_read_b64_tr_b16 v[50:51], v16 offset:28160
  ds_read_b128 v[64:67], v189 offset:15360
  s_waitcnt lgkmcnt(6)
  v_mfma_f32_32x32x16_bf16 v[68:83], v[40:43], v[56:59], v[68:83]
  s_waitcnt vmcnt(0)
  s_barrier
  ds_read_b64_tr_b16 v[36:37], v16 offset:28672
  ds_read_b64_tr_b16 v[38:39], v16 offset:29696
  ds_read_b128 v[52:55], v189 offset:16384
  s_waitcnt lgkmcnt(6)
  v_mfma_f32_32x32x16_bf16 v[68:83], v[44:47], v[60:63], v[68:83]
  ds_read_b64_tr_b16 v[40:41], v16 offset:30720
  ds_read_b64_tr_b16 v[42:43], v16 offset:31744
  ds_read_b128 v[56:59], v189 offset:17408
  s_waitcnt lgkmcnt(6)
  v_mfma_f32_32x32x16_bf16 v[68:83], v[48:51], v[64:67], v[68:83]
  ds_read_b64_tr_b16 v[44:45], v16 offset:32256
  ds_read_b64_tr_b16 v[46:47], v16 offset:33280
  ds_read_b128 v[60:63], v189 offset:18432
  s_waitcnt lgkmcnt(6)
  v_mfma_f32_32x32x16_bf16 v[68:83], v[36:39], v[52:55], v[68:83]
  ds_read_b64_tr_b16 v[48:49], v16 offset:34304
  ds_read_b64_tr_b16 v[50:51], v16 offset:35328
  ds_read_b128 v[64:67], v189 offset:19456
  s_waitcnt lgkmcnt(6)
  v_mfma_f32_32x32x16_bf16 v[68:83], v[40:43], v[56:59], v[68:83]
  ds_read_b64_tr_b16 v[36:37], v16 offset:35840
  ds_read_b64_tr_b16 v[38:39], v16 offset:36864
  ds_read_b128 v[52:55], v189 offset:20480
  s_waitcnt lgkmcnt(6)
  v_mfma_f32_32x32x16_bf16 v[68:83], v[44:47], v[60:63], v[68:83]
  ds_read_b64_tr_b16 v[40:41], v16 offset:37888
  ds_read_b64_tr_b16 v[42:43], v16 offset:38912
  ds_read_b128 v[56:59], v189 offset:21504
  s_waitcnt lgkmcnt(6)
  v_mfma_f32_32x32x16_bf16 v[68:83], v[48:51], v[64:67], v[68:83]
  ds_read_b64_tr_b16 v[44:45], v16 offset:39424
  ds_read_b64_tr_b16 v[46:47], v16 offset:40448
  ds_read_b128 v[60:63], v189 offset:22528
  s_waitcnt lgkmcnt(6)
  v_mfma_f32_32x32x16_bf16 v[68:83], v[36:39], v[52:55], v[68:83]
  ds_read_b64_tr_b16 v[48:49], v16 offset:41472
  ds_read_b64_tr_b16 v[50:51], v16 offset:42496
  ds_read_b128 v[64:67], v189 offset:23552
  s_waitcnt lgkmcnt(6)
  v_mfma_f32_32x32x16_bf16 v[68:83], v[40:43], v[56:59], v[68:83]
  ds_read_b64_tr_b16 v[36:37], v16 offset:43008
  ds_read_b64_tr_b16 v[38:39], v16 offset:44032
  ds_read_b128 v[52:55], v189 offset:24576
  s_waitcnt lgkmcnt(6)
  v_mfma_f32_32x32x16_bf16 v[68:83], v[44:47], v[60:63], v[68:83]
  ds_read_b64_tr_b16 v[40:41], v16 offset:45056
  ds_read_b64_tr_b16 v[42:43], v16 offset:46080
  ds_read_b128 v[56:59], v189 offset:25600
  s_waitcnt lgkmcnt(6)
  v_mfma_f32_32x32x16_bf16 v[68:83], v[48:51], v[64:67], v[68:83]
  ds_read_b64_tr_b16 v[44:45], v16 offset:46592
  ds_read_b64_tr_b16 v[46:47], v16 offset:47616
  ds_read_b128 v[60:63], v189 offset:26624
  s_waitcnt lgkmcnt(6)
  v_mfma_f32_32x32x16_bf16 v[68:83], v[36:39], v[52:55], v[68:83]
  ds_read_b64_tr_b16 v[48:49], v16 offset:48640
  ds_read_b64_tr_b16 v[50:51], v16 offset:49664
  ds_read_b128 v[64:67], v189 offset:27648
  s_waitcnt lgkmcnt(6)
  v_mfma_f32_32x32x16_bf16 v[68:83], v[40:43], v[56:59], v[68:83]
  ds_read_b64_tr_b16 v[36:37], v16 offset:50176
  ds_read_b64_tr_b16 v[38:39], v16 offset:51200
  ds_read_b128 v[52:55], v189 offset:28672
  s_waitcnt lgkmcnt(6)
  v_mfma_f32_32x32x16_bf16 v[68:83], v[44:47], v[60:63], v[68:83]
  ds_read_b64_tr_b16 v[40:41], v16 offset:52224
  ds_read_b64_tr_b16 v[42:43], v16 offset:53248
  ds_read_b128 v[56:59], v189 offset:29696
  s_waitcnt lgkmcnt(6)
  v_mfma_f32_32x32x16_bf16 v[68:83], v[48:51], v[64:67], v[68:83]
  ds_read_b64_tr_b16 v[44:45], v16 offset:53760
  ds_read_b64_tr_b16 v[46:47], v16 offset:54784
  ds_read_b128 v[60:63], v189 offset:30720
  s_waitcnt lgkmcnt(6)
  v_mfma_f32_32x32x16_bf16 v[68:83], v[36:39], v[52:55], v[68:83]
  ds_read_b64_tr_b16 v[48:49], v16 offset:55808
  ds_read_b64_tr_b16 v[50:51], v18 offset:56832
  ds_read_b128 v[64:67], v189 offset:31744
  s_waitcnt lgkmcnt(6)
  v_mfma_f32_32x32x16_bf16 v[68:83], v[40:43], v[56:59], v[68:83]
  s_waitcnt lgkmcnt(3)
  v_mfma_f32_32x32x16_bf16 v[68:83], v[44:47], v[60:63], v[68:83]
  s_waitcnt lgkmcnt(0)
  v_mfma_f32_32x32x16_bf16 v[68:83], v[48:51], v[64:67], v[68:83]
  s_nop 11
  v_cvt_pk_bf16_f32 v84, v68, v69
  v_cvt_pk_bf16_f32 v85, v70, v71
  v_cvt_pk_bf16_f32 v86, v72, v73
  v_cvt_pk_bf16_f32 v87, v74, v75
  v_cvt_pk_bf16_f32 v88, v76, v77
  v_cvt_pk_bf16_f32 v89, v78, v79
  v_cvt_pk_bf16_f32 v90, v80, v81
  v_cvt_pk_bf16_f32 v91, v82, v83
  s_lshl_b32 s53, s74, 1
  s_and_b32 s52, s48, 1
  s_add_u32 s53, s53, s52
  v_permlane32_swap_b32 v84, v86
  v_permlane32_swap_b32 v85, v87
  v_permlane32_swap_b32 v88, v90
  v_permlane32_swap_b32 v89, v91
  s_mul_i32 s72, s68, 57344
  s_lshl_b32 s52, s53, 6
  s_add_u32 s72, s72, s52
  s_add_u32 s72, s72, 896
  buffer_store_dwordx4 v[84:87], v190, s[36:39], s72 offen nt
  buffer_store_dwordx4 v[88:91], v190, s[36:39], s72 offen offset:32 nt
L_end:
  s_endpgm
L_slowA:
  s_or_b32 s4, s4, 1
  s_mov_b32 s12, 0
  s_sub_u32 s10, s89, 8
  s_max_i32 s10, s10, 0
  s_sub_u32 s6, s89, s10
  s_add_u32 s6, s6, 1
  s_lshl_b32 s5, s67, 6
  s_add_u32 s5, s5, s10
  s_lshl_b32 s5, s5, 12
  s_add_u32 s5, s5, 4194304
  s_cmp_ge_u32 s89, 8
  s_cselect_b32 s7, 3, 2
  s_branch L_slow
L_slowB:
  s_or_b32 s4, s4, 2
  s_mov_b32 s12, 1
  s_mov_b32 s6, 64
  s_lshl_b32 s5, s67, 18
  s_mov_b32 s7, 0
  v_mov_b32 v20, v68
  v_mov_b32 v21, v69
  v_mov_b32 v22, v70
  v_mov_b32 v23, v71
  v_mov_b32 v24, v72
  v_mov_b32 v25, v73
  v_mov_b32 v26, v74
  v_mov_b32 v27, v75
L_slow:
  s_waitcnt vmcnt(0) lgkmcnt(0)
  s_mov_b32 exec_lo, 0
  v_mov_b32 v26, 0
  v_mov_b32 v27, 0
  s_mov_b32 exec_lo, -1
  v_mov_b32 v6, 0xff800000
  s_mov_b32 s10, 0
  s_mov_b32 s11, s5
L_sl1:
  buffer_load_dwordx4 a[240:243], v2, s[32:35], s11 offen sc1
  buffer_load_dwordx4 a[244:247], v2, s[32:35], s11 offen offset:1024 sc1
  s_waitcnt vmcnt(0)
  v_mfma_f32_32x32x16_bf16 v[208:223], a[240:243], v[20:23], 0
  v_mfma_f32_32x32x16_bf16 v[208:223], a[244:247], v[24:27], v[208:223]
  s_nop 15
  s_cmp_eq_u32 s10, 0
  s_cselect_b32 s52, s7, 0
  s_bitcmp1_b32 s52, 0
  s_cbranch_scc0 L_ne1
  v_add_f32 v208, v208, v192
  v_add_f32 v209, v209, v193
  v_add_f32 v210, v210, v194
  v_add_f32 v211, v211, v195
  v_add_f32 v212, v212, v196
  v_add_f32 v213, v213, v197
  v_add_f32 v214, v214, v198
  v_add_f32 v215, v215, v199
  v_add_f32 v216, v216, v200
  v_add_f32 v217, v217, v201
  v_add_f32 v218, v218, v202
  v_add_f32 v219, v219, v203
  v_add_f32 v220, v220, v204
  v_add_f32 v221, v221, v205
  v_add_f32 v222, v222, v206
  v_add_f32 v223, v223, v207
L_ne1:
  s_add_u32 s52, s10, 1
  s_cmp_eq_u32 s52, s6
  s_cselect_b32 s52, s7, 0
  s_bitcmp1_b32 s52, 1
  s_cbranch_scc0 L_nd1
  v_add_f32 v208, v208, v240
  v_add_f32 v209, v209, v241
  v_add_f32 v210, v210, v242
  v_add_f32 v211, v211, v243
  v_add_f32 v212, v212, v244
  v_add_f32 v213, v213, v245
  v_add_f32 v214, v214, v246
  v_add_f32 v215, v215, v247
  v_add_f32 v216, v216, v248
  v_add_f32 v217, v217, v249
  v_add_f32 v218, v218, v250
  v_add_f32 v219, v219, v251
  v_add_f32 v220, v220, v252
  v_add_f32 v221, v221, v253
  v_add_f32 v222, v222, v254
  v_add_f32 v223, v223, v255
L_nd1:
  v_max3_f32 v6, v6, v208, v209
  v_max3_f32 v6, v6, v210, v211
  v_max3_f32 v6, v6, v212, v213
  v_max3_f32 v6, v6, v214, v215
  v_max3_f32 v6, v6, v216, v217
  v_max3_f32 v6, v6, v218, v219
  v_max3_f32 v6, v6, v220, v221
  v_max3_f32 v6, v6, v222, v223
  s_add_u32 s11, s11, 4096
  s_add_u32 s10, s10, 1
  s_cmp_lt_u32 s10, s6
  s_cbranch_scc1 L_sl1
  v_mov_b32 v3, v6
  s_nop 1
  v_permlane32_swap_b32 v6, v3
  v_max_f32 v6, v6, v3
  v_and_b32 v3, 0xffff0000, v6
  v_sub_f32 v4, v6, v3
  v_and_b32 v5, 0xffff0000, v4
  v_sub_f32 v4, v4, v5
  v_lshrrev_b32 v3, 16, v3
  v_or_b32 v3, v3, v5
  v_xor_b32 v3, 0x80008000, v3
  v_lshrrev_b32 v4, 16, v4
  v_xor_b32 v4, 0x8000, v4
  s_mov_b32 exec_lo, 0
  v_mov_b32 v26, v3
  v_mov_b32 v27, v4
  s_mov_b32 exec_lo, -1
  v_mov_b32 v224, 0
  v_mov_b32 v225, 0
  v_mov_b32 v226, 0
  v_mov_b32 v227, 0
  v_mov_b32 v228, 0
  v_mov_b32 v229, 0
  v_mov_b32 v230, 0
  v_mov_b32 v231, 0
  v_mov_b32 v232, 0
  v_mov_b32 v233, 0
  v_mov_b32 v234, 0
  v_mov_b32 v235, 0
  v_mov_b32 v236, 0
  v_mov_b32 v237, 0
  v_mov_b32 v238, 0
  v_mov_b32 v239, 0
  s_mov_b32 s10, 0
  s_mov_b32 s11, s5
L_sl2:
  buffer_load_dwordx4 a[240:243], v2, s[32:35], s11 offen sc1
  buffer_load_dwordx4 a[244:247], v2, s[32:35], s11 offen offset:1024 sc1
  buffer_load_dwordx4 a[248:251], v2, s[32:35], s11 offen offset:2048 sc1
  buffer_load_dwordx4 a[252:255], v2, s[32:35], s11 offen offset:3072 sc1
  s_waitcnt vmcnt(0)
  v_mfma_f32_32x32x16_bf16 v[208:223], a[240:243], v[20:23], 0
  v_mfma_f32_32x32x16_bf16 v[208:223], a[244:247], v[24:27], v[208:223]
  s_nop 15
  s_cmp_eq_u32 s10, 0
  s_cselect_b32 s52, s7, 0
  s_bitcmp1_b32 s52, 0
  s_cbranch_scc0 L_ne2
  v_add_f32 v208, v208, v192
  v_add_f32 v209, v209, v193
  v_add_f32 v210, v210, v194
  v_add_f32 v211, v211, v195
  v_add_f32 v212, v212, v196
  v_add_f32 v213, v213, v197
  v_add_f32 v214, v214, v198
  v_add_f32 v215, v215, v199
  v_add_f32 v216, v216, v200
  v_add_f32 v217, v217, v201
  v_add_f32 v218, v218, v202
  v_add_f32 v219, v219, v203
  v_add_f32 v220, v220, v204
  v_add_f32 v221, v221, v205
  v_add_f32 v222, v222, v206
  v_add_f32 v223, v223, v207
L_ne2:
  s_add_u32 s52, s10, 1
  s_cmp_eq_u32 s52, s6
  s_cselect_b32 s52, s7, 0
  s_bitcmp1_b32 s52, 1
  s_cbranch_scc0 L_nd2
  v_add_f32 v208, v208, v240
  v_add_f32 v209, v209, v241
  v_add_f32 v210, v210, v242
  v_add_f32 v211, v211, v243
  v_add_f32 v212, v212, v244
  v_add_f32 v213, v213, v245
  v_add_f32 v214, v214, v246
  v_add_f32 v215, v215, v247
  v_add_f32 v216, v216, v248
  v_add_f32 v217, v217, v249
  v_add_f32 v218, v218, v250
  v_add_f32 v219, v219, v251
  v_add_f32 v220, v220, v252
  v_add_f32 v221, v221, v253
  v_add_f32 v222, v222, v254
  v_add_f32 v223, v223, v255
L_nd2:
  v_exp_f32 v208, v208
  v_exp_f32 v209, v209
  v_exp_f32 v210, v210
  v_exp_f32 v211, v211
  v_exp_f32 v212, v212
  v_exp_f32 v213, v213
  v_exp_f32 v214, v214
  v_exp_f32 v215, v215
  v_exp_f32 v216, v216
  v_exp_f32 v217, v217
  v_exp_f32 v218, v218
  v_exp_f32 v219, v219
  v_exp_f32 v220, v220
  v_exp_f32 v221, v221
  v_exp_f32 v222, v222
  v_exp_f32 v223, v223
  s_nop 0
  v_cvt_pk_bf16_f32 v28, v208, v209
  v_cvt_pk_bf16_f32 v29, v210, v211
  v_cvt_pk_bf16_f32 v30, v212, v213
  v_cvt_pk_bf16_f32 v31, v214, v215
  v_cvt_pk_bf16_f32 v32, v216, v217
  v_cvt_pk_bf16_f32 v33, v218, v219
  v_cvt_pk_bf16_f32 v34, v220, v221
  v_cvt_pk_bf16_f32 v35, v222, v223
  s_nop 1
  v_mfma_f32_32x32x16_bf16 v[224:239], a[248:251], v[28:31], v[224:239]
  v_mfma_f32_32x32x16_bf16 v[224:239], a[252:255], v[32:35], v[224:239]
  s_nop 15
  s_add_u32 s11, s11, 4096
  s_add_u32 s10, s10, 1
  s_cmp_lt_u32 s10, s6
  s_cbranch_scc1 L_sl2
  s_cmp_eq_u32 s12, 0
  s_cbranch_scc1 L_finA
  v_mov_b32 v36, v224
  v_mov_b32 v37, v225
  v_mov_b32 v38, v226
  v_mov_b32 v39, v227
  v_mov_b32 v40, v228
  v_mov_b32 v41, v229
  v_mov_b32 v42, v230
  v_mov_b32 v43, v231
  v_mov_b32 v44, v232
  v_mov_b32 v45, v233
  v_mov_b32 v46, v234
  v_mov_b32 v47, v235
  v_mov_b32 v48, v236
  v_mov_b32 v49, v237
  v_mov_b32 v50, v238
  v_mov_b32 v51, v239
  s_branch L_finB
.section .rodata,"a"
.p2align 6
.amdhsa_kernel concat_heads__sliding_block__softmax_full_mha__prompt_kernel
  .amdhsa_next_free_vgpr 512
  .amdhsa_next_free_sgpr 102
  .amdhsa_accum_offset 256
  .amdhsa_group_segment_fixed_size 0
  .amdhsa_kernarg_size 72
  .amdhsa_user_sgpr_count 2
  .amdhsa_user_sgpr_kernarg_segment_ptr 1
  .amdhsa_system_sgpr_workgroup_id_x 1
.end_amdhsa_kernel
```
